```python
import torch

def _softmax(x, axis=-1):
    return torch.softmax(x, dim=axis)
def _gelu(x):
    return torch.nn.functional.gelu(x, approximate="tanh")
def _silu(x):
    return torch.nn.functional.silu(x)
def _sigmoid(x):
    return torch.sigmoid(x)
def _layernorm(x, axis=-1, eps=1e-5):
    m = x.mean(dim=axis, keepdim=True)
    v = x.var(dim=axis, keepdim=True, unbiased=False)
    return (x - m) / torch.sqrt(v + eps)
def _scatter_add(tgt, idx, src, axis=0):
    return tgt.clone().index_add_(axis, idx, src)
def _segment_sum(src, seg, n):
    out = torch.zeros((n,) + src.shape[1:], dtype=src.dtype)
    return out.index_add_(0, seg, src)
def _pad(x, pw):
    flat = tuple(v for pair in reversed(pw) for v in pair)
    return torch.nn.functional.pad(x, flat)

kernel_name = 'sequential_preLN__ssm_conv_s4d__moe_arch_mod__prompt'

def setup_inputs():

    _w = (lambda a: (lambda t: t.to(torch.bfloat16) if t.is_floating_point() else t)(torch.as_tensor(a)))
    def _A_setup():
        Bsz, L, D, N = 1, 2048, 512, 128
        return {
            "u": _w((lambda *s: torch.randn(*s, dtype=torch.bfloat16) * 0.05)(Bsz, L, D)),
            "log_A_real": _w((lambda *s: torch.randn(*s, dtype=torch.bfloat16) * 6.4)(D, N) * 0.5),
            "A_imag": _w((lambda *s: torch.randn(*s, dtype=torch.bfloat16) * 0.05)(D, N) * 3.14),
            "C_real": _w((lambda *s: torch.randn(*s, dtype=torch.bfloat16) * 0.05)(D, N) / N ** 0.5),
            "C_imag": _w((lambda *s: torch.randn(*s, dtype=torch.bfloat16) * 0.05)(D, N) / N ** 0.5),
            "log_dt": _w((lambda *s: torch.randn(*s, dtype=torch.bfloat16) * 0.05)(D) * 0.5 - 4.0),
            "D_skip": _w((lambda *s: torch.randn(*s, dtype=torch.bfloat16) * 0.05)(D)),
        }
    _A_in = _A_setup()

    def _B_setup():
        B, S, D, F, C = 1, 2048, 512, 1792, 1
        return {
            "x": _w((lambda *s: torch.randn(*s, dtype=torch.bfloat16) * 0.05)(B, S, D)),
            "w_r": _w((lambda *s: torch.randn(*s, dtype=torch.bfloat16) * 0.05)(D)),
            "w_gate": _w((lambda *s: torch.randn(*s, dtype=torch.bfloat16) * 0.05)(D, F)),
            "w_up": _w((lambda *s: torch.randn(*s, dtype=torch.bfloat16) * 0.05)(D, F)),
            "w_down": _w((lambda *s: torch.randn(*s, dtype=torch.bfloat16) * 0.05)(F, D)),
        }
    _B_in = _B_setup()

    return {
        "A_u": _A_in["u"],
        "A_log_A_real": _A_in["log_A_real"],
        "A_A_imag": _A_in["A_imag"],
        "A_C_real": _A_in["C_real"],
        "A_C_imag": _A_in["C_imag"],
        "A_log_dt": _A_in["log_dt"],
        "A_D_skip": _A_in["D_skip"],
        "B_x": _B_in["x"],
        "B_w_r": _B_in["w_r"],
        "B_w_gate": _B_in["w_gate"],
        "B_w_up": _B_in["w_up"],
        "B_w_down": _B_in["w_down"],
    }

def reference(A_u, A_log_A_real, A_A_imag, A_C_real, A_C_imag, A_log_dt, A_D_skip, B_x, B_w_r, B_w_gate, B_w_up, B_w_down):
    def _A_ref(u, log_A_real, A_imag, C_real, C_imag, log_dt, D_skip):
        L = u.shape[1]
        dt = torch.exp(log_dt)
        A = -torch.exp(log_A_real) + 1j * A_imag
        C = (C_real + 1j * C_imag) * dt[:, None]
        pos = (lambda x, dt: x.to(dt))(torch.arange(L), log_dt.dtype)
        P = torch.exp((A * dt[:, None])[:, :, None] * pos[None, None, :])
        K = 2.0 * torch.einsum("dn,dnl->dl", C, P).real
        L2 = 2 * L
        u_t = (lambda x, *d: x.permute(*d))(u, 0, 2, 1)
        Kf = (lambda x, *a, **k: torch.fft.rfft(x.float(), *a, **k))(K, L2)
        Uf = (lambda x, *a, **k: torch.fft.rfft(x.float(), *a, **k))(u_t, L2)
        y = (lambda x, *a, **k: torch.fft.irfft(x, *a, **k).to(torch.bfloat16))(Uf * Kf[None, :, :], L2)[:, :, :L]
        y = (lambda x, *d: x.permute(*d))(y, 0, 2, 1)
        return y + u * D_skip[None, None, :]

    def _B_ref(x, w_r, w_gate, w_up, w_down):
        B, S, D = x.shape
        C = 1
        r = x @ w_r
        idx = torch.argsort(-r, axis=-1)[:, :C]
        idx_e = (lambda x, n, axis: torch.repeat_interleave(x, n, dim=axis))(idx.reshape(B, C, 1), D, axis=2)
        x_sel = (lambda x, i, axis: torch.take_along_dim(x, i, dim=axis))(x, idx_e, axis=1)
        g = _silu(x_sel @ w_gate)
        u = x_sel @ w_up
        y = (g * u) @ w_down
        r_sel = _sigmoid((lambda x, i, axis: torch.take_along_dim(x, i, dim=axis))(r, idx, axis=1))
        y = y * r_sel.reshape(B, C, 1)
        b_off = (torch.arange(B) * S).reshape(B, 1)
        flat_idx = (idx + b_off).reshape(B * C)
        zero = (x * 0.0).reshape(B * S, D)
        upd = _scatter_add(zero, flat_idx, y.reshape(B * C, D), axis=0)
        return x + upd.reshape(B, S, D)

    x = A_u
    h = x + _A_ref(_layernorm(x, axis=-1), A_log_A_real, A_A_imag, A_C_real, A_C_imag, A_log_dt, A_D_skip)
    h2 = h + _B_ref(_layernorm(h, axis=-1), B_w_r, B_w_gate, B_w_up, B_w_down)
    return h2
```

```asm
; @launch grid=(256,1,1) block=(512,1,1) lds=90272
.amdgcn_target "amdgcn-amd-amdhsa--gfx950"
.text
.globl sequential_preLN__ssm_conv_s4d__moe_arch_mod__prompt_kernel
.p2align 8
.type sequential_preLN__ssm_conv_s4d__moe_arch_mod__prompt_kernel,@function
sequential_preLN__ssm_conv_s4d__moe_arch_mod__prompt_kernel:
    s_cmp_ge_u32 s2, 256
    s_cbranch_scc1 L_end
    s_getpc_b64 s[64:65]
L_pc:
    v_lshlrev_b32_e64 v2, 5, v0
    v_min_u32 v2, L_codeend-L_pc-4, v2
    global_load_dword v3, v2, s[64:65]
    s_load_dwordx16 s[4:19], s[0:1], 0
    s_load_dwordx8 s[20:27], s[0:1], 64
    s_load_dwordx4 s[28:31], s[0:1], 96
    s_load_dwordx2 s[32:33], s[0:1], 112
    v_lshrrev_b32 v4, 6, v0
    s_and_b32 s36, s2, 7
    v_readfirstlane_b32 s37, v4
    s_lshr_b32 s35, s2, 3
    s_lshl_b32 s34, s36, 5
    s_add_u32 s34, s34, s35
    v_and_b32_e64 v1, 63, v0
    s_mov_b32 s49, 0xffff0000
    s_cmp_ge_u32 s37, 4
    s_cbranch_scc1 L_chan
    v_lshrrev_b32 v32, 1, v0
    v_and_b32 v33, 1, v0
    v_lshlrev_b32 v34, 3, v32
    s_lshl_b32 s40, s34, 13
    v_lshl_add_u32 v23, v33, 12, v34
    v_add_u32_e64 v23, s40, v23
    s_mul_i32 s71, s34, 20608
    s_add_u32 s71, s71, 229376
    s_add_u32 s40, s71, 4096
    v_lshl_add_u32 v22, v0, 4, s40
    v_lshlrev_b32 v35, 4, v1
    s_waitcnt lgkmcnt(0)
    global_load_dwordx2 v[212:213], v23, s[4:5] offset:0 nt
    global_load_dwordx2 v[214:215], v23, s[4:5] offset:1024 nt
    global_load_dwordx2 v[216:217], v23, s[4:5] offset:2048 nt
    global_load_dwordx2 v[218:219], v23, s[4:5] offset:3072 nt
    s_load_dword s38, s[32:33], 0
    global_load_dwordx2 v[18:19], v34, s[16:17]
    global_load_dwordx2 v[20:21], v34, s[20:21]
    global_load_dwordx4 v[96:99], v35, s[20:21]
    s_mov_b32 s44, 0xaaaaaaaa
    s_mov_b32 s45, 0xaaaaaaaa
    s_mov_b32 s46, 0x3f80
    s_mov_b32 s47, 0x3f800000
    s_mov_b32 s48, 0x3f803f80
    s_mov_b32 s18, 0x5080
    s_mov_b32 s19, 0x50800000
    s_and_b32 s66, s34, 1
    s_lshl_b32 s66, s66, 12
    s_lshr_b32 s67, s34, 1
    s_lshl_b32 s67, s67, 5
    s_add_u32 s66, s66, s67
    s_add_u32 s66, s66, 229376
    v_mul_u32_u24 v24, 20608, v32
    v_lshl_add_u32 v24, v33, 4, v24
    v_add_u32_e64 v24, s66, v24
    v_add_u32 v25, 2637824, v24
    v_lshlrev_b32 v27, 6, v33
    v_and_b32 v35, 4, v1
    v_lshl_add_u32 v27, v35, 3, v27
    v_and_b32_e64 v35, 8, v1
    v_lshl_add_u32 v27, v35, 4, v27
    v_lshrrev_b32_e64 v35, 5, v1
    v_lshl_add_u32 v27, v35, 4, v27
    s_lshl_b32 s66, s37, 2
    s_add_u32 s66, s66, 89344
    v_add_u32 v27, s66, v27
    v_and_b32 v35, 7, v1
    v_lshlrev_b32 v28, 4, v35
    v_add_u32 v28, 89344, v28
    v_lshlrev_b32_e64 v30, 3, v0
    v_mov_b32 v29, 0x9fff9fff
    v_mov_b32 v100, 0
    v_mov_b32 v101, 0
    v_min_u32 v35, 472, v30
    v_add_u32 v35, 80064, v35
    v_min_u32_e64 v36, 56, v30
    v_add_u32 v36, 69632, v36
    ds_write2st64_b64 v35, v[100:101], v[100:101] offset0:0 offset1:9
    ds_write_b64 v36, v[100:101]
    ds_write_b64 v36, v[100:101] offset:4416
    v_min_u32 v36, 232, v30
    v_add_u32 v36, 73808, v36
    ds_write_b64 v36, v[100:101]
    ds_write_b64 v36, v[100:101] offset:4416
    v_min_u32 v36, 1592, v30
    v_add_u32 v36, 78464, v36
    ds_write_b64 v36, v[100:101]
    v_add_u32 v30, 80544, v30
    s_waitcnt lgkmcnt(0)
    s_add_u32 s38, s38, 1
    s_add_u32 s56, s38, 0
    s_and_b32 s56, s56, 15
    s_mul_i32 s56, s56, 0x08002000
    s_and_b32 s56, s56, 0x60006000
    s_add_u32 s57, s38, 5
    s_and_b32 s57, s57, 15
    s_mul_i32 s57, s57, 0x08002000
    s_and_b32 s57, s57, 0x60006000
    s_add_u32 s58, s38, 10
    s_and_b32 s58, s58, 15
    s_mul_i32 s58, s58, 0x08002000
    s_and_b32 s58, s58, 0x60006000
    s_add_u32 s59, s38, 15
    s_and_b32 s59, s59, 15
    s_mul_i32 s59, s59, 0x08002000
    s_and_b32 s59, s59, 0x60006000
    s_waitcnt vmcnt(3)
    s_nop 0
    v_dot2_f32_bf16 v100, v212, s48, 0
    v_dot2_f32_bf16 v101, v214, s48, 0
    v_dot2_f32_bf16 v102, v216, s48, 0
    v_dot2_f32_bf16 v103, v218, s48, 0
    v_dot2_f32_bf16 v104, v212, v212, 0
    v_dot2_f32_bf16 v105, v214, v214, 0
    v_dot2_f32_bf16 v106, v216, v216, 0
    v_dot2_f32_bf16 v107, v218, v218, 0
    v_dot2_f32_bf16 v100, v213, s48, v100
    v_dot2_f32_bf16 v101, v215, s48, v101
    v_dot2_f32_bf16 v102, v217, s48, v102
    v_dot2_f32_bf16 v103, v219, s48, v103
    v_dot2_f32_bf16 v104, v213, v213, v104
    v_dot2_f32_bf16 v105, v215, v215, v105
    v_dot2_f32_bf16 v106, v217, v217, v106
    v_dot2_f32_bf16 v107, v219, v219, v107
    v_add_f32_dpp v100, v100, v100 row_ror:8 row_mask:0xf bank_mask:0x3
    v_add_f32_dpp v101, v101, v101 row_ror:8 row_mask:0xf bank_mask:0x3
    v_add_f32_dpp v102, v102, v102 row_ror:8 row_mask:0xf bank_mask:0x3
    v_add_f32_dpp v103, v103, v103 row_ror:8 row_mask:0xf bank_mask:0x3
    v_add_f32_dpp v100, v104, v104 row_ror:8 row_mask:0xf bank_mask:0xc
    v_add_f32_dpp v101, v105, v105 row_ror:8 row_mask:0xf bank_mask:0xc
    v_add_f32_dpp v102, v106, v106 row_ror:8 row_mask:0xf bank_mask:0xc
    v_add_f32_dpp v103, v107, v107 row_ror:8 row_mask:0xf bank_mask:0xc
    v_add_f32_dpp v100, v100, v100 row_shl:4 row_mask:0xf bank_mask:0x5
    v_add_f32_dpp v101, v101, v101 row_shl:4 row_mask:0xf bank_mask:0x5
    s_nop 0
    v_add_f32_dpp v100, v102, v102 row_shr:4 row_mask:0xf bank_mask:0xa
    v_add_f32_dpp v101, v103, v103 row_shr:4 row_mask:0xf bank_mask:0xa
    s_nop 1
    v_permlane32_swap_b32 v100, v101
    v_add_f32_e64 v100, v100, v101
    s_nop 1
    v_add_f32_dpp v100, v100, v100 quad_perm:[2,3,0,1] row_mask:0xf bank_mask:0xf
    v_mov_b32 v108, v100
    s_nop 1
    v_permlane16_swap_b32 v100, v108
    v_add_f32 v100, v100, v108
    ds_write_b32 v27, v100
    s_waitcnt lgkmcnt(0)
    s_barrier
    ds_read_b128 v[100:103], v28
    ds_read_b128 v[104:107], v28 offset:128
    s_mov_b64 vcc, s[44:45]
    s_waitcnt lgkmcnt(0)
    v_pk_add_f32 v[100:101], v[100:101], v[102:103]
    v_pk_add_f32 v[104:105], v[104:105], v[106:107]
    v_add_f32 v100, v100, v101
    v_add_f32 v104, v104, v105
    v_mul_f32 v100, 0x3b000000, v100
    v_mul_f32 v104, 0x3b000000, v104
    v_fma_f32 v104, -v100, v100, v104
    v_max_f32_e64 v104, 0, v104
    v_cvt_pk_bf16_f32 v112, -v100, v104
    v_and_b32_e64 v104, s49, v112
    v_add_f32 v104, 0x3727c5ac, v104
    v_cvt_pk_bf16_f32 v104, v104, v104
    v_and_b32 v104, s49, v104
    v_sqrt_f32 v104, v104
    v_lshlrev_b32_e64 v110, 16, v112
    v_cvt_pk_bf16_f32 v104, v104, v104
    v_and_b32_e64 v104, s49, v104
    v_mul_f32 v104, 0x61800000, v104
    v_rcp_f32_e64 v111, v104
    v_mov_b32_dpp v124, v110 row_newbcast:4 row_mask:0xf bank_mask:0xf
    v_mov_b32_dpp v125, v110 row_newbcast:5 row_mask:0xf bank_mask:0xf
    v_mov_b32_dpp v126, v110 row_newbcast:6 row_mask:0xf bank_mask:0xf
    v_mov_b32_dpp v127, v110 row_newbcast:7 row_mask:0xf bank_mask:0xf
    v_cndmask_b32_dpp v116, v110, v124, vcc row_newbcast:0 row_mask:0xf bank_mask:0xf
    v_cndmask_b32_dpp v117, v110, v125, vcc row_newbcast:1 row_mask:0xf bank_mask:0xf
    v_cndmask_b32_dpp v118, v110, v126, vcc row_newbcast:2 row_mask:0xf bank_mask:0xf
    v_cndmask_b32_dpp v119, v110, v127, vcc row_newbcast:3 row_mask:0xf bank_mask:0xf
    v_dot2_f32_bf16 v132, v212, s46, v116
    v_dot2_f32_bf16 v133, v214, s46, v117
    v_dot2_f32_bf16 v134, v216, s46, v118
    v_dot2_f32_bf16 v135, v218, s46, v119
    v_dot2_f32_bf16 v136, v212, s47, v116
    v_dot2_f32_bf16 v137, v214, s47, v117
    v_dot2_f32_bf16 v138, v216, s47, v118
    v_dot2_f32_bf16 v139, v218, s47, v119
    v_dot2_f32_bf16 v140, v213, s46, v116
    v_dot2_f32_bf16 v141, v215, s46, v117
    v_dot2_f32_bf16 v142, v217, s46, v118
    v_dot2_f32_bf16 v143, v219, s46, v119
    v_dot2_f32_bf16 v144, v213, s47, v116
    v_dot2_f32_bf16 v145, v215, s47, v117
    v_dot2_f32_bf16 v146, v217, s47, v118
    v_dot2_f32_bf16 v147, v219, s47, v119
    v_mov_b32_dpp v124, v111 row_newbcast:4 row_mask:0xf bank_mask:0xf
    v_mov_b32_dpp v125, v111 row_newbcast:5 row_mask:0xf bank_mask:0xf
    v_mov_b32_dpp v126, v111 row_newbcast:6 row_mask:0xf bank_mask:0xf
    v_mov_b32_dpp v127, v111 row_newbcast:7 row_mask:0xf bank_mask:0xf
    v_cndmask_b32_dpp v120, v111, v124, vcc row_newbcast:0 row_mask:0xf bank_mask:0xf
    v_cndmask_b32_dpp v121, v111, v125, vcc row_newbcast:1 row_mask:0xf bank_mask:0xf
    v_cndmask_b32_dpp v122, v111, v126, vcc row_newbcast:2 row_mask:0xf bank_mask:0xf
    v_cndmask_b32_dpp v123, v111, v127, vcc row_newbcast:3 row_mask:0xf bank_mask:0xf
    v_pk_mul_f32 v[132:133], v[132:133], v[120:121]
    v_pk_mul_f32 v[134:135], v[134:135], v[122:123]
    v_pk_mul_f32 v[136:137], v[136:137], v[120:121]
    v_pk_mul_f32 v[138:139], v[138:139], v[122:123]
    v_cvt_pk_bf16_f32 v10, v132, v133
    v_cvt_pk_bf16_f32 v11, v134, v135
    v_cvt_pk_bf16_f32 v12, v136, v137
    v_cvt_pk_bf16_f32 v13, v138, v139
    v_and_or_b32 v148, v10, v29, s56
    v_and_or_b32 v149, v11, v29, s57
    v_and_or_b32 v150, v12, v29, s58
    v_and_or_b32 v151, v13, v29, s59
    s_barrier
    s_nop 0
    global_store_dwordx4 v22, v[148:151], s[32:33] offset:-4096 sc1
    v_pk_mul_f32 v[140:141], v[140:141], v[120:121]
    v_pk_mul_f32 v[142:143], v[142:143], v[122:123]
    v_pk_mul_f32 v[144:145], v[144:145], v[120:121]
    v_pk_mul_f32 v[146:147], v[146:147], v[122:123]
    v_cvt_pk_bf16_f32 v14, v140, v141
    v_cvt_pk_bf16_f32 v15, v142, v143
    v_cvt_pk_bf16_f32 v16, v144, v145
    v_cvt_pk_bf16_f32 v17, v146, v147
    v_and_or_b32 v152, v14, v29, s56
    v_and_or_b32 v153, v15, v29, s57
    v_and_or_b32 v154, v16, v29, s58
    v_and_or_b32 v155, v17, v29, s59
    global_store_dwordx4 v22, v[152:155], s[32:33] offset:0 sc1
    s_barrier
    s_waitcnt vmcnt(2)
    s_mul_i32 s43, s36, 14
    s_add_u32 s43, s43, s35
    s_bitcmp1_b32 s37, 0
    s_cselect_b64 s[50:51], s[24:25], s[22:23]
    s_lshr_b32 s67, s37, 1
    s_mul_i32 s67, s67, 917504
    s_lshl_b32 s68, s43, 5
    s_add_u32 s67, s67, s68
    v_lshrrev_b32 v108, 1, v1
    v_mul_u32_u24 v108, 28672, v108
    v_lshl_add_u32 v108, v33, 4, v108
    v_add_u32_e64 v108, s67, v108
    v_add_u32 v110, 25088, v108
    v_add_u32 v109, 14336, v108
    v_add_u32 v108, 3584, v108
    s_lshl_b32 s67, s43, 14
    s_add_u32 s67, s67, 4096
    s_cmp_lt_u32 s35, 14
    s_cselect_b32 s67, s67, 4096
    s_cselect_b32 s68, 4, 0
    v_mul_u32_u24 v220, s68, v0
    v_add_u32_e64 v220, s67, v220
    v_add_u32 v221, 8192, v220
    v_dot2_f32_bf16 v104, v96, s48, 0
    v_dot2_f32_bf16 v104, v97, s48, v104
    v_dot2_f32_bf16 v104, v98, s48, v104
    v_dot2_f32_bf16 v104, v99, s48, v104
    v_mov_b32 v105, 89984
    s_mov_b32 s54, 0x05040100
    s_mov_b32 s55, 0x07060302
    v_add_f32_dpp v104, v104, v104 row_ror:8 row_mask:0xf bank_mask:0xf
    s_nop 1
    v_add_f32_dpp v104, v104, v104 row_ror:4 row_mask:0xf bank_mask:0xf
    s_nop 1
    v_add_f32_dpp v104, v104, v104 row_ror:2 row_mask:0xf bank_mask:0xf
    s_nop 1
    v_add_f32_dpp v104, v104, v104 row_ror:1 row_mask:0xf bank_mask:0xf
    s_nop 1
    v_add_f32_dpp v104, v104, v104 row_bcast:15 row_mask:0xa bank_mask:0xf
    s_nop 1
    v_add_f32_dpp v104, v104, v104 row_bcast:31 row_mask:0xc bank_mask:0xf
    s_mov_b32 exec_lo, 0
    s_brev_b32 exec_hi, 1
    ds_write_b32 v105, v104
    s_mov_b64 exec, -1
    global_load_dwordx4 v[88:91], v24, s[32:33] sc1
    global_load_dwordx4 v[92:95], v25, s[32:33] sc1
    s_barrier
    s_waitcnt vmcnt(0)
    v_xor_b32 v132, s56, v88
    v_xor_b32 v133, s57, v89
    v_xor_b32 v134, s58, v90
    v_xor_b32 v135, s59, v91
    v_xor_b32 v136, s56, v92
    v_xor_b32 v137, s57, v93
    v_xor_b32 v138, s58, v94
    v_xor_b32 v139, s59, v95
    ds_write2st64_b64 v30, v[132:133], v[134:135] offset0:0 offset1:9
    ds_write2st64_b64 v30, v[136:137], v[138:139] offset0:4 offset1:13
    v_or3_b32 v38, v132, v133, v134
    v_or3_b32 v39, v135, v136, v137
    v_or3_b32 v38, v38, v138, v139
    v_or_b32_e64 v38, v38, v39
    v_and_b32 v38, 0x60006000, v38
    s_nop 1
    v_or_b32_dpp v38, v38, v38 quad_perm:[1,0,3,2] row_mask:0xf bank_mask:0xf
    v_cmp_ne_u32_e64 vcc, 0, v38
    s_cbranch_vccnz L_retry_x1
L_ok_x1:
    s_waitcnt lgkmcnt(0)
    s_barrier
    s_cmp_lt_u32 s35, 14
    s_cbranch_scc0 L_now
    global_load_dwordx4 v[40:43], v108, s[50:51] offset:-3584
    global_load_dwordx4 v[44:47], v108, s[50:51] offset:0
    global_load_dwordx4 v[48:51], v108, s[50:51] offset:3584
    global_load_dwordx4 v[52:55], v109, s[50:51] offset:-3584
    global_load_dwordx4 v[56:59], v109, s[50:51] offset:0
    global_load_dwordx4 v[60:63], v109, s[50:51] offset:3584
    global_load_dwordx4 v[64:67], v110, s[50:51] offset:-3584
    global_load_dwordx4 v[68:71], v110, s[50:51] offset:0
L_now:
    s_mul_i32 s66, s34, 7168
    s_mul_i32 s67, s37, 1792
    s_add_u32 s66, s66, s67
    v_min_u32 v36, 13, v1
    v_lshl_add_u32 v36, v36, 7, s66
    s_mov_b64 exec, 0xffff
    global_load_dword v3, v36, s[26:27]
    s_mov_b64 exec, -1
    s_barrier
    s_barrier
    v_and_b32 v35, 0xfe, v0
    v_mul_u32_u24 v24, 20608, v35
    v_lshl_add_u32 v24, v33, 4, v24
    s_lshl_b32 s66, s34, 5
    s_add_u32 s66, s66, 237568
    v_add_u32_e64 v24, s66, v24
    v_add_u32 v25, 20608, v24
    v_lshlrev_b32 v140, 16, v10
    v_and_b32 v141, s49, v10
    v_lshlrev_b32 v142, 16, v11
    v_and_b32 v143, s49, v11
    v_lshlrev_b32 v144, 16, v12
    v_and_b32 v145, s49, v12
    v_lshlrev_b32 v146, 16, v13
    v_and_b32 v147, s49, v13
    v_lshlrev_b32 v148, 16, v14
    v_and_b32 v149, s49, v14
    v_lshlrev_b32 v150, 16, v15
    v_and_b32 v151, s49, v15
    v_lshlrev_b32 v152, 16, v16
    v_and_b32 v153, s49, v16
    v_lshlrev_b32 v154, 16, v17
    v_and_b32 v155, s49, v17
    v_lshlrev_b32 v172, 16, v18
    v_and_b32 v173, s49, v18
    v_lshlrev_b32 v174, 16, v19
    v_and_b32 v175, s49, v19
    v_mul_f32 v172, s19, v172
    v_mul_f32 v173, s19, v173
    v_mul_f32 v174, s19, v174
    v_mul_f32 v175, s19, v175
    v_pk_mul_f32 v[140:141], v[172:173], v[140:141] op_sel_hi:[0,1]
    v_pk_mul_f32 v[142:143], v[172:173], v[142:143] op_sel_hi:[0,1]
    v_pk_mul_f32 v[144:145], v[172:173], v[144:145] op_sel:[1,0] op_sel_hi:[1,1]
    v_pk_mul_f32 v[146:147], v[172:173], v[146:147] op_sel:[1,0] op_sel_hi:[1,1]
    v_pk_mul_f32 v[148:149], v[174:175], v[148:149] op_sel_hi:[0,1]
    v_pk_mul_f32 v[150:151], v[174:175], v[150:151] op_sel_hi:[0,1]
    v_pk_mul_f32 v[152:153], v[174:175], v[152:153] op_sel:[1,0] op_sel_hi:[1,1]
    v_pk_mul_f32 v[154:155], v[174:175], v[154:155] op_sel:[1,0] op_sel_hi:[1,1]
    v_pk_mul_f32 v[140:141], s[18:19], v[140:141] op_sel:[1,0] op_sel_hi:[1,1]
    v_pk_mul_f32 v[142:143], s[18:19], v[142:143] op_sel:[1,0] op_sel_hi:[1,1]
    v_pk_mul_f32 v[144:145], s[18:19], v[144:145] op_sel:[1,0] op_sel_hi:[1,1]
    v_pk_mul_f32 v[146:147], s[18:19], v[146:147] op_sel:[1,0] op_sel_hi:[1,1]
    v_pk_mul_f32 v[148:149], s[18:19], v[148:149] op_sel:[1,0] op_sel_hi:[1,1]
    v_pk_mul_f32 v[150:151], s[18:19], v[150:151] op_sel:[1,0] op_sel_hi:[1,1]
    v_pk_mul_f32 v[152:153], s[18:19], v[152:153] op_sel:[1,0] op_sel_hi:[1,1]
    v_pk_mul_f32 v[154:155], s[18:19], v[154:155] op_sel:[1,0] op_sel_hi:[1,1]
    v_cvt_pk_bf16_f32 v156, v140, v141
    v_cvt_pk_bf16_f32 v157, v142, v143
    v_cvt_pk_bf16_f32 v158, v144, v145
    v_cvt_pk_bf16_f32 v159, v146, v147
    v_cvt_pk_bf16_f32 v160, v148, v149
    v_cvt_pk_bf16_f32 v161, v150, v151
    v_cvt_pk_bf16_f32 v162, v152, v153
    v_cvt_pk_bf16_f32 v163, v154, v155
    v_lshlrev_b32 v140, 16, v156
    v_and_b32 v141, s49, v156
    v_lshlrev_b32 v142, 16, v157
    v_and_b32 v143, s49, v157
    v_lshlrev_b32 v144, 16, v158
    v_and_b32 v145, s49, v158
    v_lshlrev_b32 v146, 16, v159
    v_and_b32 v147, s49, v159
    v_lshlrev_b32 v148, 16, v160
    v_and_b32 v149, s49, v160
    v_lshlrev_b32 v150, 16, v161
    v_and_b32 v151, s49, v161
    v_lshlrev_b32 v152, 16, v162
    v_and_b32 v153, s49, v162
    v_lshlrev_b32 v154, 16, v163
    v_and_b32 v155, s49, v163
    v_lshlrev_b32 v156, 16, v212
    v_and_b32 v160, s49, v212
    v_lshlrev_b32 v164, 16, v213
    v_and_b32 v168, s49, v213
    v_lshlrev_b32 v157, 16, v214
    v_and_b32 v161, s49, v214
    v_lshlrev_b32 v165, 16, v215
    v_and_b32 v169, s49, v215
    v_lshlrev_b32 v158, 16, v216
    v_and_b32 v162, s49, v216
    v_lshlrev_b32 v166, 16, v217
    v_and_b32 v170, s49, v217
    v_lshlrev_b32 v159, 16, v218
    v_and_b32 v163, s49, v218
    v_lshlrev_b32 v167, 16, v219
    v_and_b32 v171, s49, v219
    v_pk_add_f32 v[156:157], v[156:157], v[140:141]
    v_pk_add_f32 v[158:159], v[158:159], v[142:143]
    v_pk_add_f32 v[160:161], v[160:161], v[144:145]
    v_pk_add_f32 v[162:163], v[162:163], v[146:147]
    v_pk_add_f32 v[164:165], v[164:165], v[148:149]
    v_pk_add_f32 v[166:167], v[166:167], v[150:151]
    v_pk_add_f32 v[168:169], v[168:169], v[152:153]
    v_pk_add_f32 v[170:171], v[170:171], v[154:155]
    s_mul_i32 s66, s37, 6528
    s_add_u32 s66, s66, 40960
    v_mul_u32_u24 v30, 1088, v33
    v_lshrrev_b32_e64 v35, 1, v1
    v_lshl_add_u32 v30, v35, 3, v30
    v_add_u32 v30, s66, v30
    v_lshrrev_b32 v35, 4, v1
    v_and_b32_e64 v36, 15, v1
    v_lshl_add_u32 v37, v36, 4, s66
    s_movk_i32 s66, 272
    v_mad_u32_u24 v31, v35, s66, v37
    s_movk_i32 s66, 2176
    v_mad_u32_u24 v29, v35, s66, v37
    v_lshlrev_b32_e64 v36, 4, v36
    v_lshl_add_u32 v36, v35, 10, v36
    s_lshl_b32 s66, s37, 8
    s_add_u32 s67, s66, s71
    s_add_u32 s67, s67, 16384
    v_add_u32_e64 v26, s67, v36
    s_lshl_b32 s67, s34, 13
    s_add_u32 s66, s66, s67
    s_add_u32 s66, s66, 4096
    v_add_u32_e64 v23, s66, v36
    s_lshr_b32 s66, s37, 1
    s_lshl_b32 s66, s66, 9
    s_add_u32 s66, s66, 245760
    v_lshrrev_b32_e64 v4, 1, v1
    v_lshl_add_u32 v4, v4, 4, s66
    v_lshlrev_b32 v5, 6, v33
    v_and_b32 v6, 12, v1
    v_lshl_add_u32 v5, v6, 2, v5
    v_lshrrev_b32_e64 v6, 5, v1
    v_lshl_add_u32 v5, v6, 3, v5
    s_and_b32 s66, s37, 1
    s_lshl_b32 s66, s66, 7
    s_lshr_b32 s67, s37, 1
    s_lshl_b32 s67, s67, 2
    s_add_u32 s66, s66, s67
    s_add_u32 s66, s66, 90016
    v_add_u32 v5, s66, v5
    v_and_b32 v6, 15, v1
    v_lshlrev_b32 v6, 3, v6
    v_add_u32 v6, 90016, v6
    s_add_u32 s66, s71, 18432
    v_lshl_add_u32 v7, v0, 3, s66
    v_mov_b32 v8, 90000
    s_waitcnt vmcnt(1)
    s_nop 0
    v_perm_b32 v180, v44, v40, s54
    v_perm_b32 v181, v44, v40, s55
    v_perm_b32 v182, v45, v41, s54
    v_perm_b32 v183, v45, v41, s55
    v_perm_b32 v184, v46, v42, s54
    v_perm_b32 v185, v46, v42, s55
    v_perm_b32 v186, v47, v43, s54
    v_perm_b32 v187, v47, v43, s55
    v_perm_b32 v188, v52, v48, s54
    v_perm_b32 v189, v52, v48, s55
    v_perm_b32 v190, v53, v49, s54
    v_perm_b32 v191, v53, v49, s55
    v_perm_b32 v192, v54, v50, s54
    v_perm_b32 v193, v54, v50, s55
    v_perm_b32 v194, v55, v51, s54
    v_perm_b32 v195, v55, v51, s55
    v_perm_b32 v196, v60, v56, s54
    v_perm_b32 v197, v60, v56, s55
    v_perm_b32 v198, v61, v57, s54
    v_perm_b32 v199, v61, v57, s55
    v_perm_b32 v200, v62, v58, s54
    v_perm_b32 v201, v62, v58, s55
    v_perm_b32 v202, v63, v59, s54
    v_perm_b32 v203, v63, v59, s55
    v_perm_b32 v204, v68, v64, s54
    v_perm_b32 v205, v68, v64, s55
    v_perm_b32 v206, v69, v65, s54
    v_perm_b32 v207, v69, v65, s55
    v_perm_b32 v208, v70, v66, s54
    v_perm_b32 v209, v70, v66, s55
    v_perm_b32 v210, v71, v67, s54
    v_perm_b32 v211, v71, v67, s55
    global_load_dwordx4 v[88:91], v24, s[32:33] sc1
    global_load_dwordx4 v[92:95], v25, s[32:33] sc1
    s_waitcnt vmcnt(0)
    v_max3_u32 v38, v88, v89, v90
    v_max3_u32 v39, v91, v92, v93
    v_max3_u32 v38, v38, v94, v95
    v_max_u32 v38, v38, v39
    v_cmp_eq_u32 vcc, -1, v38
    s_cbranch_vccnz L_retry_x2
L_ok_x2:
    v_dot2_f32_bf16 v156, v88, s18, v156
    v_dot2_f32_bf16 v157, v88, s19, v157
    v_dot2_f32_bf16 v158, v89, s18, v158
    v_dot2_f32_bf16 v159, v89, s19, v159
    v_dot2_f32_bf16 v160, v90, s18, v160
    v_dot2_f32_bf16 v161, v90, s19, v161
    v_dot2_f32_bf16 v162, v91, s18, v162
    v_dot2_f32_bf16 v163, v91, s19, v163
    v_dot2_f32_bf16 v164, v92, s18, v164
    v_dot2_f32_bf16 v165, v92, s19, v165
    v_dot2_f32_bf16 v166, v93, s18, v166
    v_dot2_f32_bf16 v167, v93, s19, v167
    v_dot2_f32_bf16 v168, v94, s18, v168
    v_dot2_f32_bf16 v169, v94, s19, v169
    v_dot2_f32_bf16 v170, v95, s18, v170
    v_dot2_f32_bf16 v171, v95, s19, v171
    v_cvt_pk_bf16_f32 v212, v156, v160
    v_cvt_pk_bf16_f32 v214, v157, v161
    v_cvt_pk_bf16_f32 v216, v158, v162
    v_cvt_pk_bf16_f32 v218, v159, v163
    v_cvt_pk_bf16_f32 v213, v164, v168
    v_cvt_pk_bf16_f32 v215, v165, v169
    v_cvt_pk_bf16_f32 v217, v166, v170
    v_cvt_pk_bf16_f32 v219, v167, v171
    v_dot2_f32_bf16 v100, v212, s48, 0
    v_dot2_f32_bf16 v101, v214, s48, 0
    v_dot2_f32_bf16 v102, v216, s48, 0
    v_dot2_f32_bf16 v103, v218, s48, 0
    v_dot2_f32_bf16 v104, v212, v212, 0
    v_dot2_f32_bf16 v105, v214, v214, 0
    v_dot2_f32_bf16 v106, v216, v216, 0
    v_dot2_f32_bf16 v107, v218, v218, 0
    v_dot2_f32_bf16 v108, v212, v20, 0
    v_dot2_f32_bf16 v109, v214, v20, 0
    v_dot2_f32_bf16 v110, v216, v20, 0
    v_dot2_f32_bf16 v111, v218, v20, 0
    v_dot2_f32_bf16 v100, v213, s48, v100
    v_dot2_f32_bf16 v101, v215, s48, v101
    v_dot2_f32_bf16 v102, v217, s48, v102
    v_dot2_f32_bf16 v103, v219, s48, v103
    v_dot2_f32_bf16 v104, v213, v213, v104
    v_dot2_f32_bf16 v105, v215, v215, v105
    v_dot2_f32_bf16 v106, v217, v217, v106
    v_dot2_f32_bf16 v107, v219, v219, v107
    v_dot2_f32_bf16 v108, v213, v21, v108
    v_dot2_f32_bf16 v109, v215, v21, v109
    v_dot2_f32_bf16 v110, v217, v21, v110
    v_dot2_f32_bf16 v111, v219, v21, v111
    v_add_f32_dpp v100, v100, v100 row_ror:8 row_mask:0xf bank_mask:0x3
    v_add_f32_dpp v101, v101, v101 row_ror:8 row_mask:0xf bank_mask:0x3
    v_add_f32_dpp v102, v102, v102 row_ror:8 row_mask:0xf bank_mask:0x3
    v_add_f32_dpp v103, v103, v103 row_ror:8 row_mask:0xf bank_mask:0x3
    v_add_f32_dpp v100, v104, v104 row_ror:8 row_mask:0xf bank_mask:0xc
    v_add_f32_dpp v101, v105, v105 row_ror:8 row_mask:0xf bank_mask:0xc
    v_add_f32_dpp v102, v106, v106 row_ror:8 row_mask:0xf bank_mask:0xc
    v_add_f32_dpp v103, v107, v107 row_ror:8 row_mask:0xf bank_mask:0xc
    v_add_f32_dpp v108, v108, v108 row_shl:4 row_mask:0xf bank_mask:0x5
    v_add_f32_dpp v109, v109, v109 row_shl:4 row_mask:0xf bank_mask:0x5
    s_nop 0
    s_nop 0
    v_add_f32_dpp v108, v110, v110 row_shr:4 row_mask:0xf bank_mask:0xa
    v_add_f32_dpp v109, v111, v111 row_shr:4 row_mask:0xf bank_mask:0xa
    v_add_f32_dpp v100, v100, v100 row_shl:4 row_mask:0xf bank_mask:0x5
    v_add_f32_dpp v101, v101, v101 row_shl:4 row_mask:0xf bank_mask:0x5
    s_nop 0
    v_add_f32_dpp v100, v102, v102 row_shr:4 row_mask:0xf bank_mask:0xa
    v_add_f32_dpp v101, v103, v103 row_shr:4 row_mask:0xf bank_mask:0xa
    v_permlane32_swap_b32 v108, v109
    v_and_b32 v113, 0xffffff7f, v27
    v_permlane32_swap_b32 v100, v101
    v_add_f32 v108, v108, v109
    v_add_f32 v100, v100, v101
    s_mov_b64 vcc, s[44:45]
    v_add_f32_dpp v108, v108, v108 row_ror:8 row_mask:0xf bank_mask:0xf
    v_add_f32_dpp v100, v100, v100 quad_perm:[2,3,0,1] row_mask:0xf bank_mask:0xf
    v_mov_b32_e64 v101, v100
    v_add_f32_dpp v108, v108, v108 quad_perm:[2,3,0,1] row_mask:0xf bank_mask:0xf
    v_mov_b32 v109, v108
    v_permlane16_swap_b32 v100, v101
    v_add_f32 v100, v100, v101
    v_permlane16_swap_b32 v108, v109
    v_add_f32_e64 v108, v108, v109
    ds_write_b32 v27, v100 offset:256
    ds_write_b32 v113, v108 offset:512
    s_waitcnt lgkmcnt(0)
    s_barrier
    global_load_dword v72, v220, s[26:27] offset:-4096
    global_load_dword v73, v220, s[26:27] offset:-3072
    global_load_dword v74, v220, s[26:27] offset:-2048
    global_load_dword v75, v220, s[26:27] offset:-1024
    global_load_dword v76, v220, s[26:27] offset:0
    global_load_dword v77, v220, s[26:27] offset:1024
    global_load_dword v78, v220, s[26:27] offset:2048
    global_load_dword v79, v220, s[26:27] offset:3072
    global_load_dword v80, v221, s[26:27] offset:-4096
    global_load_dword v81, v221, s[26:27] offset:-3072
    global_load_dword v82, v221, s[26:27] offset:-2048
    global_load_dword v83, v221, s[26:27] offset:-1024
    global_load_dword v84, v221, s[26:27] offset:0
    global_load_dword v85, v221, s[26:27] offset:1024
    global_load_dword v86, v221, s[26:27] offset:2048
    global_load_dword v87, v221, s[26:27] offset:3072
    v_mov_b32 v114, 89984
    ds_read_b128 v[100:103], v28 offset:256
    ds_read_b128 v[104:107], v28 offset:384
    ds_read_b128 v[108:111], v28 offset:512
    ds_read_b32 v115, v114
    s_lshl_b32 s66, s34, 3
    s_sub_u32 s66, 2047, s66
    v_and_b32 v114, 7, v1
    v_sub_u32 v114, s66, v114
    s_waitcnt lgkmcnt(2)
    v_pk_add_f32 v[100:101], v[100:101], v[102:103]
    v_pk_add_f32 v[104:105], v[104:105], v[106:107]
    v_add_f32 v100, v100, v101
    v_add_f32 v104, v104, v105
    v_mul_f32 v100, 0x3b000000, v100
    v_mul_f32 v104, 0x3b000000, v104
    v_fma_f32 v104, -v100, v100, v104
    v_max_f32_e64 v104, 0, v104
    v_cvt_pk_bf16_f32 v128, -v100, v104
    v_and_b32_e64 v104, s49, v128
    v_add_f32 v104, 0x3727c5ac, v104
    v_cvt_pk_bf16_f32 v104, v104, v104
    v_and_b32 v104, s49, v104
    v_sqrt_f32 v104, v104
    v_lshlrev_b32_e64 v112, 16, v128
    v_cvt_pk_bf16_f32 v104, v104, v104
    v_and_b32 v104, s49, v104
    v_rcp_f32_e64 v113, v104
    s_waitcnt lgkmcnt(0)
    v_pk_add_f32 v[108:109], v[108:109], v[110:111]
    v_add_f32 v108, v108, v109
    v_fmac_f32 v108, v112, v115
    v_mul_f32 v108, v108, v113
    v_ashrrev_i32 v109, 31, v108
    v_or_b32 v109, 0x80000000, v109
    v_xor_b32_e64 v108, v108, v109
    v_and_b32 v108, 0xfffff800, v108
    v_or_b32 v108, v108, v114
    v_min_u32_e64 v108, -2, v108
    s_nop 1
    v_max_u32_dpp v108, v108, v108 quad_perm:[1,0,3,2] row_mask:0xf bank_mask:0xf
    s_nop 1
    v_max_u32_dpp v108, v108, v108 quad_perm:[2,3,0,1] row_mask:0xf bank_mask:0xf
    s_nop 1
    v_max_u32_dpp v108, v108, v108 row_half_mirror row_mask:0xf bank_mask:0xf
    ds_write_b64 v30, v[212:213] offset:2176
    ds_write_b64 v30, v[214:215] offset:2448
    ds_write_b64 v30, v[216:217] offset:2720
    ds_write_b64 v30, v[218:219] offset:2992
    v_mov_b32_dpp v124, v112 row_newbcast:4 row_mask:0xf bank_mask:0xf
    v_mov_b32_dpp v125, v112 row_newbcast:5 row_mask:0xf bank_mask:0xf
    v_mov_b32_dpp v126, v112 row_newbcast:6 row_mask:0xf bank_mask:0xf
    v_mov_b32_dpp v127, v112 row_newbcast:7 row_mask:0xf bank_mask:0xf
    v_cndmask_b32_dpp v116, v112, v124, vcc row_newbcast:0 row_mask:0xf bank_mask:0xf
    v_cndmask_b32_dpp v117, v112, v125, vcc row_newbcast:1 row_mask:0xf bank_mask:0xf
    v_cndmask_b32_dpp v118, v112, v126, vcc row_newbcast:2 row_mask:0xf bank_mask:0xf
    v_cndmask_b32_dpp v119, v112, v127, vcc row_newbcast:3 row_mask:0xf bank_mask:0xf
    v_readfirstlane_b32 s52, v108
    v_lshlrev_b32 v156, 16, v212
    v_and_b32 v157, s49, v212
    v_lshlrev_b32 v158, 16, v213
    v_and_b32 v159, s49, v213
    v_lshlrev_b32 v160, 16, v214
    v_and_b32 v161, s49, v214
    v_lshlrev_b32 v162, 16, v215
    v_and_b32 v163, s49, v215
    v_lshlrev_b32 v164, 16, v216
    v_and_b32 v165, s49, v216
    v_lshlrev_b32 v166, 16, v217
    v_and_b32 v167, s49, v217
    v_lshlrev_b32 v168, 16, v218
    v_and_b32 v169, s49, v218
    v_lshlrev_b32 v170, 16, v219
    v_and_b32_e64 v171, s49, v219
    v_mov_b32_dpp v124, v113 row_newbcast:4 row_mask:0xf bank_mask:0xf
    v_mov_b32_dpp v125, v113 row_newbcast:5 row_mask:0xf bank_mask:0xf
    v_mov_b32_dpp v126, v113 row_newbcast:6 row_mask:0xf bank_mask:0xf
    v_mov_b32_dpp v127, v113 row_newbcast:7 row_mask:0xf bank_mask:0xf
    v_cndmask_b32_dpp v120, v113, v124, vcc row_newbcast:0 row_mask:0xf bank_mask:0xf
    v_cndmask_b32_dpp v121, v113, v125, vcc row_newbcast:1 row_mask:0xf bank_mask:0xf
    v_cndmask_b32_dpp v122, v113, v126, vcc row_newbcast:2 row_mask:0xf bank_mask:0xf
    v_cndmask_b32_dpp v123, v113, v127, vcc row_newbcast:3 row_mask:0xf bank_mask:0xf
    v_pk_add_f32 v[140:141], v[116:117], v[156:157] op_sel_hi:[0,1]
    v_pk_add_f32 v[142:143], v[116:117], v[158:159] op_sel_hi:[0,1]
    v_pk_add_f32 v[144:145], v[116:117], v[160:161] op_sel:[1,0] op_sel_hi:[1,1]
    v_pk_add_f32 v[146:147], v[116:117], v[162:163] op_sel:[1,0] op_sel_hi:[1,1]
    v_pk_add_f32 v[148:149], v[118:119], v[164:165] op_sel_hi:[0,1]
    v_pk_add_f32 v[150:151], v[118:119], v[166:167] op_sel_hi:[0,1]
    v_pk_add_f32 v[152:153], v[118:119], v[168:169] op_sel:[1,0] op_sel_hi:[1,1]
    v_pk_add_f32 v[154:155], v[118:119], v[170:171] op_sel:[1,0] op_sel_hi:[1,1]
    v_cvt_pk_bf16_f32 v10, v140, v141
    v_cvt_pk_bf16_f32 v11, v142, v143
    v_cvt_pk_bf16_f32 v12, v144, v145
    v_cvt_pk_bf16_f32 v13, v146, v147
    v_cvt_pk_bf16_f32 v14, v148, v149
    v_cvt_pk_bf16_f32 v15, v150, v151
    v_cvt_pk_bf16_f32 v16, v152, v153
    v_cvt_pk_bf16_f32 v17, v154, v155
    v_lshlrev_b32 v140, 16, v10
    v_and_b32 v141, s49, v10
    v_lshlrev_b32 v142, 16, v11
    v_and_b32 v143, s49, v11
    v_lshlrev_b32 v144, 16, v12
    v_and_b32 v145, s49, v12
    v_lshlrev_b32 v146, 16, v13
    v_and_b32 v147, s49, v13
    v_lshlrev_b32 v148, 16, v14
    v_and_b32 v149, s49, v14
    v_lshlrev_b32 v150, 16, v15
    v_and_b32 v151, s49, v15
    v_lshlrev_b32 v152, 16, v16
    v_and_b32 v153, s49, v16
    v_lshlrev_b32 v154, 16, v17
    v_and_b32 v155, s49, v17
    v_pk_mul_f32 v[140:141], v[120:121], v[140:141] op_sel_hi:[0,1]
    v_pk_mul_f32 v[142:143], v[120:121], v[142:143] op_sel_hi:[0,1]
    v_pk_mul_f32 v[144:145], v[120:121], v[144:145] op_sel:[1,0] op_sel_hi:[1,1]
    v_pk_mul_f32 v[146:147], v[120:121], v[146:147] op_sel:[1,0] op_sel_hi:[1,1]
    v_pk_mul_f32 v[148:149], v[122:123], v[148:149] op_sel_hi:[0,1]
    v_pk_mul_f32 v[150:151], v[122:123], v[150:151] op_sel_hi:[0,1]
    v_pk_mul_f32 v[152:153], v[122:123], v[152:153] op_sel:[1,0] op_sel_hi:[1,1]
    v_pk_mul_f32 v[154:155], v[122:123], v[154:155] op_sel:[1,0] op_sel_hi:[1,1]
    v_cvt_pk_bf16_f32 v10, v140, v141
    v_cvt_pk_bf16_f32 v11, v142, v143
    v_cvt_pk_bf16_f32 v12, v144, v145
    v_cvt_pk_bf16_f32 v13, v146, v147
    v_cvt_pk_bf16_f32 v14, v148, v149
    v_cvt_pk_bf16_f32 v15, v150, v151
    v_cvt_pk_bf16_f32 v16, v152, v153
    v_cvt_pk_bf16_f32 v17, v154, v155
    ds_write_b64 v30, v[10:11] offset:0
    ds_write_b64 v30, v[12:13] offset:272
    ds_write_b64 v30, v[14:15] offset:544
    ds_write_b64 v30, v[16:17] offset:816
    s_andn2_b32 s66, 7, s52
    s_mul_i32 s67, s66, 272
    v_add_u32 v29, s67, v29
    ds_read_b128 v[124:127], v29
    s_mov_b32 s3, s66
    s_mov_b32 exec_hi, 0
    s_waitcnt lgkmcnt(0)
    global_store_dwordx4 v26, v[124:127], s[32:33] sc1
    s_mov_b32 exec_hi, -1
    v_dot2_f32_bf16 v156, v10, s46, v156
    v_dot2_f32_bf16 v157, v10, s47, v157
    v_dot2_f32_bf16 v158, v11, s46, v158
    v_dot2_f32_bf16 v159, v11, s47, v159
    v_dot2_f32_bf16 v160, v12, s46, v160
    v_dot2_f32_bf16 v161, v12, s47, v161
    v_dot2_f32_bf16 v162, v13, s46, v162
    v_dot2_f32_bf16 v163, v13, s47, v163
    v_dot2_f32_bf16 v164, v14, s46, v164
    v_dot2_f32_bf16 v165, v14, s47, v165
    v_dot2_f32_bf16 v166, v15, s46, v166
    v_dot2_f32_bf16 v167, v15, s47, v167
    v_dot2_f32_bf16 v168, v16, s46, v168
    v_dot2_f32_bf16 v169, v16, s47, v169
    v_dot2_f32_bf16 v170, v17, s46, v170
    v_dot2_f32_bf16 v171, v17, s47, v171
    v_cvt_pk_bf16_f32 v88, v156, v157
    v_cvt_pk_bf16_f32 v89, v158, v159
    v_cvt_pk_bf16_f32 v90, v160, v161
    v_cvt_pk_bf16_f32 v91, v162, v163
    v_cvt_pk_bf16_f32 v92, v164, v165
    v_cvt_pk_bf16_f32 v93, v166, v167
    v_cvt_pk_bf16_f32 v94, v168, v169
    v_cvt_pk_bf16_f32 v95, v170, v171
    ds_write_b64 v30, v[88:89] offset:4352
    ds_write_b64 v30, v[90:91] offset:4624
    ds_write_b64 v30, v[92:93] offset:4896
    ds_write_b64 v30, v[94:95] offset:5168
    ds_read_b128 v[10:13], v31 offset:4352
    ds_read_b128 v[14:17], v31 offset:5440
    s_and_b32 s67, s3, 3
    s_lshl_b32 s67, s67, 4
    s_mov_b64 s[64:65], 0xffff
    s_lshl_b64 s[64:65], s[64:65], s67
    s_lshr_b32 s3, s3, 2
    s_barrier
    s_waitcnt lgkmcnt(0)
    s_cmp_eq_u32 s3, 0
    s_cselect_b64 vcc, s[64:65], 0
    s_not_b64 exec, vcc
    global_store_dwordx4 v23, v[10:13], s[28:29] offset:-4096 sc1
    s_cmp_eq_u32 s3, 1
    s_cselect_b64 vcc, s[64:65], 0
    s_not_b64 exec, vcc
    global_store_dwordx4 v23, v[14:17], s[28:29] offset:0 sc1
    s_mov_b64 exec, -1
    s_waitcnt vmcnt(3)
    v_perm_b32 v40, v73, v72, s54
    v_perm_b32 v41, v73, v72, s55
    v_perm_b32 v42, v75, v74, s54
    v_perm_b32 v43, v75, v74, s55
    v_perm_b32 v44, v77, v76, s54
    v_perm_b32 v45, v77, v76, s55
    v_perm_b32 v46, v79, v78, s54
    v_perm_b32 v47, v79, v78, s55
    v_perm_b32 v48, v81, v80, s54
    v_perm_b32 v49, v81, v80, s55
    v_perm_b32 v50, v83, v82, s54
    v_perm_b32 v51, v83, v82, s55
    v_perm_b32 v52, v85, v84, s54
    v_perm_b32 v53, v85, v84, s55
    v_perm_b32 v54, v87, v86, s54
    v_perm_b32 v55, v87, v86, s55
    s_barrier
    ds_read_b32 v100, v8
    s_cmp_lt_u32 s35, 14
    s_cselect_b64 vcc, -1, 0
    s_waitcnt lgkmcnt(0)
    v_readfirstlane_b32 s53, v100
    s_andn2_b32 s40, 2047, s53
    s_lshr_b32 s41, s40, 3
    s_mul_i32 s41, s41, 20608
    v_add_u32 v32, s41, v4
    s_mov_b64 exec, vcc
    global_load_dwordx4 v[100:103], v32, s[32:33] sc1
    s_mov_b64 exec, -1
    s_cmp_lt_u32 s35, 14
    s_cbranch_scc0 L_noffn
    s_waitcnt vmcnt(0)
    v_max3_u32 v38, v100, v101, v102
    v_max_u32 v38, v38, v103
    v_cmp_eq_u32_e64 vcc, -1, v38
    s_cbranch_vccnz L_retry_sel
L_ok_sel:
    v_dot2_f32_bf16 v108, v100, v180, 0
    v_dot2_f32_bf16 v109, v100, v181, 0
    v_dot2_f32_bf16 v110, v100, v182, 0
    v_dot2_f32_bf16 v111, v100, v183, 0
    v_dot2_f32_bf16 v112, v100, v184, 0
    v_dot2_f32_bf16 v113, v100, v185, 0
    v_dot2_f32_bf16 v114, v100, v186, 0
    v_dot2_f32_bf16 v115, v100, v187, 0
    v_dot2_f32_bf16 v108, v101, v188, v108
    v_dot2_f32_bf16 v109, v101, v189, v109
    v_dot2_f32_bf16 v110, v101, v190, v110
    v_dot2_f32_bf16 v111, v101, v191, v111
    v_dot2_f32_bf16 v112, v101, v192, v112
    v_dot2_f32_bf16 v113, v101, v193, v113
    v_dot2_f32_bf16 v114, v101, v194, v114
    v_dot2_f32_bf16 v115, v101, v195, v115
    v_dot2_f32_bf16 v108, v102, v196, v108
    v_dot2_f32_bf16 v109, v102, v197, v109
    v_dot2_f32_bf16 v110, v102, v198, v110
    v_dot2_f32_bf16 v111, v102, v199, v111
    v_dot2_f32_bf16 v112, v102, v200, v112
    v_dot2_f32_bf16 v113, v102, v201, v113
    v_dot2_f32_bf16 v114, v102, v202, v114
    v_dot2_f32_bf16 v115, v102, v203, v115
    v_dot2_f32_bf16 v108, v103, v204, v108
    v_dot2_f32_bf16 v109, v103, v205, v109
    v_dot2_f32_bf16 v110, v103, v206, v110
    v_dot2_f32_bf16 v111, v103, v207, v111
    v_dot2_f32_bf16 v112, v103, v208, v112
    v_dot2_f32_bf16 v113, v103, v209, v113
    v_dot2_f32_bf16 v114, v103, v210, v114
    v_dot2_f32_bf16 v115, v103, v211, v115
    v_add_f32_dpp v108, v108, v108 row_ror:8 row_mask:0xf bank_mask:0x3
    v_add_f32_dpp v109, v109, v109 row_ror:8 row_mask:0xf bank_mask:0x3
    v_add_f32_dpp v110, v110, v110 row_ror:8 row_mask:0xf bank_mask:0x3
    v_add_f32_dpp v111, v111, v111 row_ror:8 row_mask:0xf bank_mask:0x3
    v_add_f32_dpp v108, v112, v112 row_ror:8 row_mask:0xf bank_mask:0xc
    v_add_f32_dpp v109, v113, v113 row_ror:8 row_mask:0xf bank_mask:0xc
    v_add_f32_dpp v110, v114, v114 row_ror:8 row_mask:0xf bank_mask:0xc
    v_add_f32_dpp v111, v115, v115 row_ror:8 row_mask:0xf bank_mask:0xc
    v_add_f32_dpp v108, v108, v108 row_shl:4 row_mask:0xf bank_mask:0x5
    v_add_f32_dpp v109, v109, v109 row_shl:4 row_mask:0xf bank_mask:0x5
    s_nop 0
    v_add_f32_dpp v108, v110, v110 row_shr:4 row_mask:0xf bank_mask:0xa
    v_add_f32_dpp v109, v111, v111 row_shr:4 row_mask:0xf bank_mask:0xa
    s_nop 1
    v_permlane32_swap_b32 v108, v109
    v_add_f32_e64 v108, v108, v109
    s_nop 1
    v_add_f32_dpp v108, v108, v108 quad_perm:[2,3,0,1] row_mask:0xf bank_mask:0xf
    v_mov_b32 v116, v108
    s_nop 1
    v_permlane16_swap_b32 v108, v116
    v_add_f32 v108, v108, v116
    ds_write_b32 v5, v108
    s_cmp_eq_u32 s53, s52
    s_cselect_b32 s3, 8, s3
    s_cmp_eq_u32 s3, 0
    s_cselect_b64 exec, s[64:65], 0
    global_store_dwordx4 v23, v[10:13], s[28:29] offset:-4096 sc1
    s_cmp_eq_u32 s3, 1
    s_cselect_b64 exec, s[64:65], 0
    global_store_dwordx4 v23, v[14:17], s[28:29] offset:0 sc1
    s_mov_b64 exec, -1
    s_waitcnt lgkmcnt(0)
    s_barrier
    ds_read_b64 v[100:101], v6
    ds_read_b64 v[102:103], v6 offset:128
    v_mov_b32 v104, 0
    v_mov_b32 v105, 0
    s_waitcnt lgkmcnt(0)
    v_add_f32 v100, v100, v101
    v_add_f32 v102, v102, v103
    v_cvt_pk_bf16_f32 v101, v100, v102
    v_lshlrev_b32_e64 v100, 16, v101
    v_mul_f32 v103, 0xbfb8aa3b, v100
    v_exp_f32 v103, v103
    v_and_b32 v102, s49, v101
    v_add_f32 v103, 1.0, v103
    v_rcp_f32 v103, v103
    s_nop 0
    v_mul_f32 v100, v100, v103
    v_cvt_pk_bf16_f32 v100, v100, v100
    v_and_b32 v100, s49, v100
    v_mul_f32_e64 v100, v100, v102
    s_nop 1
    v_mov_b32_dpp v101, v100 quad_perm:[1,1,3,3] row_mask:0xf bank_mask:0xf
    v_cvt_pk_bf16_f32 v100, v100, v101
    s_nop 1
    v_dot2c_f32_bf16_dpp v104, v100, v40 row_newbcast:0 row_mask:0xf bank_mask:0xf
    v_dot2c_f32_bf16_dpp v105, v100, v41 row_newbcast:0 row_mask:0xf bank_mask:0xf
    s_nop 0
    v_dot2c_f32_bf16_dpp v104, v100, v42 row_newbcast:2 row_mask:0xf bank_mask:0xf
    v_dot2c_f32_bf16_dpp v105, v100, v43 row_newbcast:2 row_mask:0xf bank_mask:0xf
    s_nop 0
    v_dot2c_f32_bf16_dpp v104, v100, v44 row_newbcast:4 row_mask:0xf bank_mask:0xf
    v_dot2c_f32_bf16_dpp v105, v100, v45 row_newbcast:4 row_mask:0xf bank_mask:0xf
    s_nop 0
    v_dot2c_f32_bf16_dpp v104, v100, v46 row_newbcast:6 row_mask:0xf bank_mask:0xf
    v_dot2c_f32_bf16_dpp v105, v100, v47 row_newbcast:6 row_mask:0xf bank_mask:0xf
    s_nop 0
    v_dot2c_f32_bf16_dpp v104, v100, v48 row_newbcast:8 row_mask:0xf bank_mask:0xf
    v_dot2c_f32_bf16_dpp v105, v100, v49 row_newbcast:8 row_mask:0xf bank_mask:0xf
    s_nop 0
    v_dot2c_f32_bf16_dpp v104, v100, v50 row_newbcast:10 row_mask:0xf bank_mask:0xf
    v_dot2c_f32_bf16_dpp v105, v100, v51 row_newbcast:10 row_mask:0xf bank_mask:0xf
    s_nop 0
    v_dot2c_f32_bf16_dpp v104, v100, v52 row_newbcast:12 row_mask:0xf bank_mask:0xf
    v_dot2c_f32_bf16_dpp v105, v100, v53 row_newbcast:12 row_mask:0xf bank_mask:0xf
    s_nop 0
    v_dot2c_f32_bf16_dpp v104, v100, v54 row_newbcast:14 row_mask:0xf bank_mask:0xf
    v_dot2c_f32_bf16_dpp v105, v100, v55 row_newbcast:14 row_mask:0xf bank_mask:0xf
    s_nop 2
    global_store_dwordx2 v7, v[104:105], s[32:33] sc1
    s_cmp_lt_u32 s35, 8
    s_cbranch_scc0 L_nofinal
    s_cmp_lt_u32 s37, 2
    s_cbranch_scc0 L_nofinal
    s_lshl_b32 s66, s36, 3
    s_add_u32 s66, s66, s35
    s_lshl_b32 s66, s66, 1
    s_add_u32 s66, s66, s37
    v_lshrrev_b32 v32, 5, v1
    v_bfe_u32 v33, v1, 4, 1
    v_lshl_add_u32 v32, v33, 1, v32
    s_lshl_b32 s67, s66, 3
    v_lshl_add_u32 v32, v32, 1, s67
    s_add_u32 s41, s41, 245760
    v_add_u32 v33, s41, v32
    global_load_ushort v120, v33, s[32:33] sc1
    global_load_ushort v121, v33, s[32:33] offset:1024 sc1
    s_lshl_b32 s67, s40, 10
    v_add_u32 v32, s67, v32
    v_min_u32_e64 v34, 55, v1
    v_mul_u32_u24 v35, 4682, v34
    v_lshrrev_b32_e64 v35, 16, v35
    v_mad_u32_u24 v34, v35, 18, v34
    v_mul_u32_u24 v34, 20608, v34
    s_lshl_b32 s67, s66, 4
    s_add_u32 s67, s67, 247808
    v_add_u32 v34, s67, v34
    v_add_u32 v35, 2637824, v34
    s_ashr_i32 s68, s53, 31
    s_not_b32 s68, s68
    s_or_b32 s68, s68, 0x80000000
    s_xor_b32 s68, s68, s53
    s_and_b32 s68, s68, 0xfffff800
    s_or_b32 s68, s68, 0x400
    v_cvt_pk_bf16_f32 v122, s68, s68
    v_and_b32 v122, s49, v122
    v_mul_f32 v122, 0xbfb8aa3b, v122
    v_exp_f32 v122, v122
    s_nop 0
    v_add_f32 v122, 1.0, v122
    v_rcp_f32_e64 v122, v122
    s_nop 0
    v_cvt_pk_bf16_f32 v122, v122, v122
    v_and_b32 v122, s49, v122
    v_mov_b32 v88, 0
    v_mov_b32 v89, 0
    v_mov_b32 v90, 0
    v_mov_b32 v91, 0
    v_mov_b32 v92, 0
    v_mov_b32 v93, 0
    v_mov_b32 v94, 0
    v_mov_b32 v95, 0
    s_waitcnt vmcnt(0)
    s_mov_b32 exec_hi, 0x00ffffff
    global_load_dwordx4 v[88:91], v34, s[32:33] sc1
    global_load_dwordx4 v[92:95], v35, s[32:33] sc1
    s_mov_b32 exec_hi, -1
    v_max_u32 v38, v120, v121
    v_cmp_eq_u32 vcc, 0xffff, v38
    s_cbranch_vccnz L_retry_xh
L_ok_xh:
    v_lshlrev_b32 v120, 16, v120
    v_lshlrev_b32 v121, 16, v121
    s_waitcnt vmcnt(0)
    v_max3_u32 v38, v88, v89, v90
    v_max3_u32 v39, v91, v92, v93
    v_max3_u32 v38, v38, v94, v95
    v_max_u32 v38, v38, v39
    v_cmp_eq_u32_e64 vcc, -1, v38
    s_cbranch_vccnz L_retry_part
L_ok_part:
    v_pk_add_f32 v[88:89], v[88:89], v[92:93]
    v_pk_add_f32 v[90:91], v[90:91], v[94:95]
    s_nop 0
    v_permlane32_swap_b32 v88, v89
    v_permlane32_swap_b32 v90, v91
    v_add_f32 v88, v88, v89
    v_add_f32 v90, v90, v91
    s_nop 1
    v_permlane16_swap_b32 v88, v90
    v_add_f32_e64 v88, v88, v90
    s_nop 1
    v_add_f32_dpp v88, v88, v88 row_ror:8 row_mask:0xf bank_mask:0xf
    s_nop 1
    v_add_f32_dpp v88, v88, v88 row_ror:4 row_mask:0xf bank_mask:0xf
    s_nop 1
    v_add_f32_dpp v88, v88, v88 row_ror:2 row_mask:0xf bank_mask:0xf
    s_nop 1
    v_add_f32_dpp v88, v88, v88 row_ror:1 row_mask:0xf bank_mask:0xf
    v_cvt_pk_bf16_f32 v88, v88, v88
    v_and_b32 v88, s49, v88
    v_mul_f32_e64 v88, v88, v122
    v_cvt_pk_bf16_f32 v88, v88, v88
    v_and_b32 v88, s49, v88
    v_add_f32 v88, v88, v120
    v_cvt_pk_bf16_f32 v88, v88, v88
    v_and_b32 v88, s49, v88
    v_add_f32 v88, v88, v121
    v_cvt_pk_bf16_f32 v88, v88, v88
    s_mov_b32 exec_lo, 0x00010001
    s_mov_b32 exec_hi, 0x00010001
    global_store_short v32, v88, s[28:29]
L_fin:
    s_endpgm
    .p2align 6
L_chan:
    v_and_b32 v0, 0xff, v0
    s_sub_u32 s37, s37, 4
    s_lshl_b32 s40, s34, 9
    v_lshl_add_u32 v28, v0, 1, s40
    s_lshl_b32 s41, s34, 2
    s_waitcnt lgkmcnt(0)
    global_load_ushort v24, v28, s[6:7] nt
    global_load_ushort v25, v28, s[8:9] nt
    global_load_ushort v26, v28, s[10:11] nt
    global_load_ushort v27, v28, s[12:13] nt
    s_load_dword s39, s[14:15], s41
    v_and_b32 v32, 15, v1
    v_lshrrev_b32 v33, 4, v1
    s_lshr_b32 s40, s37, 1
    s_and_b32 s41, s37, 1
    v_and_b32 v28, 7, v1
    v_lshlrev_b32 v15, 4, v28
    v_add_u32 v15, 89344, v15
    s_mul_i32 s66, s40, 4416
    s_lshl_b32 s67, s41, 7
    s_add_u32 s66, s66, s67
    s_add_u32 s66, s66, 69736
    v_lshlrev_b32 v28, 3, v33
    v_sub_u32 v28, v32, v28
    v_lshl_add_u32 v4, v28, 2, s66
    v_add_u32 v5, 1024, v4
    v_add_u32 v6, 2048, v4
    v_add_u32 v7, 3072, v4
    v_add_u32 v8, 4096, v4
    v_mov_b32 v40, -1
    v_mov_b32 v41, -1
    v_mov_b32 v42, -1
    v_mov_b32 v43, -1
    s_mul_i32 s66, s34, 20608
    s_add_u32 s66, s66, 233472
    v_lshl_add_u32 v44, v0, 4, s66
    v_add_u32 v45, 8192, v44
    v_add_u32 v46, 12288, v44
    s_lshl_b32 s66, s34, 4
    s_add_u32 s66, s66, 36864
    v_lshl_add_u32 v22, v1, 4, s66
    s_cmp_eq_u32 s37, 0
    s_cselect_b64 exec, 1, 0
    global_store_dwordx4 v22, v[40:43], s[32:33] sc1
    s_mov_b64 exec, -1
    global_store_dwordx4 v45, v[40:43], s[32:33] offset:-4096 sc1
    global_store_dwordx4 v45, v[40:43], s[32:33] sc1
    s_cmp_lt_u32 s35, 14
    s_cselect_b32 s66, 4, 2
    s_cmp_lt_u32 s37, s66
    s_cselect_b64 exec, -1, 1
    global_store_dwordx4 v46, v[40:43], s[32:33] sc1
    s_mov_b64 exec, -1
    v_and_b32 v28, 7, v32
    v_or_b32 v28, 0x0c0c0c00, v28
    v_cmp_gt_u32 vcc, 8, v32
    s_cmp_eq_u32 s41, 0
    s_cbranch_scc0 L_rows_hi
    v_mov_b32 v16, v32
    v_mov_b32 v72, 0xf121110
    v_mov_b32 v73, 0x3151412
    v_mov_b32 v74, 0x7161815
    v_mov_b32 v75, 0xb1d1c16
    v_perm_b32 v72, v73, v72, v28
    v_perm_b32 v74, v75, v74, v28
    v_cndmask_b32_e64 v17, v74, v72, vcc
    v_lshl_add_u32 v19, v32, 2, v33
    v_lshlrev_b32_e64 v19, 4, v19
    v_add_u32 v20, 1024, v19
    s_branch L_rows_done
L_rows_hi:
    s_nop 0
    v_mov_b32 v72, 0x19191713
    v_mov_b32 v73, 0x1b1b1a19
    v_mov_b32 v74, 0x20201f1e
    v_mov_b32 v75, 0x24242220
    v_perm_b32 v72, v73, v72, v28
    v_perm_b32 v74, v75, v74, v28
    v_cndmask_b32_e64 v16, v74, v72, vcc
    v_mov_b32 v72, 0x25252321
    v_mov_b32 v73, 0x28282726
    v_mov_b32 v74, 0x2b2b2a29
    v_mov_b32 v75, 0x2f2f2e2c
    v_perm_b32 v72, v73, v72, v28
    v_perm_b32 v74, v75, v74, v28
    v_cndmask_b32 v17, v74, v72, vcc
    v_lshrrev_b32 v30, 1, v33
    v_lshl_add_u32 v19, v30, 4, v32
    v_and_b32_e64 v30, 1, v33
    v_lshl_add_u32 v19, v19, 1, v30
    v_lshlrev_b32_e64 v19, 5, v19
    v_add_u32 v19, 2048, v19
    s_mul_i32 s66, s40, -3616
    s_add_u32 s66, s66, 8896
    v_lshl_add_u32 v20, v1, 2, s66
L_rows_done:
    s_mul_i32 s66, s40, 4416
    s_add_u32 s66, s66, 69696
    v_add_u32 v19, s66, v19
    v_add_u32 v20, s66, v20
    s_mul_i32 s66, s40, 34816
    v_lshl_add_u32 v30, v33, 4, s66
    s_movk_i32 s67, 544
    v_mad_u32_u24 v16, v16, s67, v30
    v_mad_u32_u24 v17, v17, s67, v30
    v_mad_u32_u24 v18, v32, s67, v30
    s_lshl_b32 s67, s41, 8
    s_add_u32 m0, s66, s67
    s_mul_i32 s66, s36, 448
    s_and_b32 s66, s66, 0xffffff80
    s_mul_i32 s67, s35, 57344
    s_add_u32 s66, s66, s67
    v_lshrrev_b32_e64 v30, 2, v1
    v_mul_u32_u24 v30, 3584, v30
    v_and_b32_e64 v31, 3, v1
    v_lshl_add_u32 v30, v31, 7, v30
    v_add_u32_e64 v30, s66, v30
    s_mul_i32 s66, s34, 7168
    s_mul_i32 s67, s41, 3584
    s_add_u32 s66, s66, s67
    v_min_u32 v31, 27, v1
    v_lshl_add_u32 v31, v31, 7, s66
    s_cmp_eq_u32 s41, 0
    s_cselect_b64 s[50:51], s[22:23], s[24:25]
    s_cmp_eq_u32 s40, 0
    s_cselect_b64 s[50:51], s[50:51], s[26:27]
    s_cselect_b64 vcc, -1, 0
    v_cndmask_b32 v21, v31, v30, vcc
    s_cmp_eq_u32 s41, 0
    s_cselect_b64 s[50:51], s[22:23], s[24:25]
    s_mul_i32 s66, s40, 28672
    v_add_u32 v21, s66, v30
    v_cmp_gt_u32 vcc, 32, v1
    s_nop 1
    v_cndmask_b32 v21, 0, v21, vcc
    global_load_dword v3, v21, s[50:51]
    s_mul_i32 s66, s40, 4608
    s_lshl_b32 s67, s41, 4
    s_add_u32 s66, s66, s67
    s_add_u32 s66, s66, 80496
    v_lshl_add_u32 v29, v32, 1, v33
    v_lshl_add_u32 v9, v29, 4, s66
    s_mul_i32 s66, s37, 400
    s_add_u32 s66, s66, 78520
    v_lshlrev_b32 v29, 2, v33
    v_sub_u32 v29, v32, v29
    v_lshl_add_u32 v10, v29, 2, s66
    s_lshr_b32 s66, 0x1ff, s41
    s_andn2_b32 s66, s66, s41
    s_lshl_b32 s66, s66, 4
    v_lshlrev_b32 v29, v32, s66
    v_lshlrev_b32 v30, 3, v33
    v_lshrrev_b32 v29, v30, v29
    v_bfe_u32 v30, v29, 0, 1
    v_bfe_u32 v31, v29, 1, 1
    v_lshl_add_u32 v30, v31, 16, v30
    v_mul_u32_u24 v200, 0x3f80, v30
    v_bfe_u32 v30, v29, 2, 1
    v_bfe_u32 v31, v29, 3, 1
    v_lshl_add_u32 v30, v31, 16, v30
    v_mul_u32_u24 v201, 0x3f80, v30
    v_bfe_u32 v30, v29, 4, 1
    v_bfe_u32 v31, v29, 5, 1
    v_lshl_add_u32 v30, v31, 16, v30
    v_mul_u32_u24 v202, 0x3f80, v30
    v_bfe_u32 v30, v29, 6, 1
    v_bfe_u32 v31, v29, 7, 1
    v_lshl_add_u32 v30, v31, 16, v30
    v_mul_u32_u24 v203, 0x3f80, v30
    s_mul_i32 s66, s40, 4608
    s_lshl_b32 s67, s41, 6
    s_sub_u32 s66, s66, s67
    s_add_u32 s66, s66, 80128
    v_lshl_add_u32 v34, v32, 1, v33
    v_lshl_add_u32 v12, v34, 4, s66
    v_lshl_add_u32 v34, v32, 2, v33
    v_lshrrev_b32 v29, 3, v34
    v_add_u32 v34, v34, v29
    s_mul_i32 s66, s37, 9216
    v_lshl_add_u32 v13, v34, 4, s66
    v_lshrrev_b32 v29, 3, v1
    v_add_u32 v34, v1, v29
    s_mul_i32 s66, s37, 2304
    v_lshl_add_u32 v14, v34, 4, s66
    s_mul_i32 s66, s34, 20608
    s_lshl_b32 s67, s37, 11
    s_add_u32 s66, s66, s67
    s_add_u32 s66, s66, 237568
    v_lshl_add_u32 v23, v1, 4, s66
    s_mov_b32 s64, 0x3fb8aa3b
    s_mov_b32 s65, 0x32a57060
    s_barrier
    s_waitcnt vmcnt(4) lgkmcnt(0)
    s_setprio 2
    s_lshl_b32 s66, s39, 16
    s_and_b32 s67, s39, s49
    s_cmp_lt_u32 s37, 2
    s_cselect_b32 s39, s66, s67
    v_lshlrev_b32 v72, 16, v24
    v_mov_b32_e64 v73, s39
    v_pk_mul_f32 v[74:75], v[72:73], s[64:65] op_sel_hi:[1,0]
    v_pk_fma_f32 v[76:77], v[72:73], s[64:65], v[74:75] op_sel_hi:[1,0,1] neg_lo:[0,0,1] neg_hi:[0,0,1]
    v_exp_f32 v74, v74
    v_exp_f32 v75, v75
    v_pk_fma_f32 v[76:77], s[64:65], v[72:73], v[76:77] op_sel:[1,0,0] op_sel_hi:[1,1,1]
    v_mul_f32 v76, 0x3f317218, v76
    v_mul_f32 v77, 0x3f317218, v77
    v_pk_fma_f32 v[74:75], v[74:75], v[76:77], v[74:75]
    v_cvt_pk_bf16_f32 v72, v74, v75
    v_and_b32 v78, s49, v72
    v_lshlrev_b32 v79, 16, v72
    v_lshlrev_b32 v80, 16, v25
    v_mul_f32 v79, v79, v78
    v_mul_f32_e64 v80, v80, v78
    v_mul_f32 v79, 0xbfb8aa3b, v79
    v_mul_f32_e64 v80, 0.15915494, v80
    v_mul_f32 v78, 0x51000000, v78
    v_lshlrev_b32 v130, 16, v26
    v_lshlrev_b32 v131, 16, v27
    v_mul_f32 v130, v130, v78
    v_mul_f32 v131, v131, v78
    v_exp_f32 v134, v79
    v_fract_f32 v135, v80
    v_cos_f32 v84, v135
    v_sin_f32 v85, v135
    v_mul_f32 v136, 0x41800000, v79
    v_mul_f32 v137, 0x41800000, v80
    v_exp_f32 v136, v136
    v_fract_f32 v137, v137
    v_cos_f32 v114, v137
    v_sin_f32 v115, v137
    v_mul_f32 v138, 0x43800000, v79
    v_mul_f32 v139, 0x43800000, v80
    v_exp_f32 v138, v138
    v_fract_f32 v139, v139
    v_cos_f32 v116, v139
    v_sin_f32 v117, v139
    v_pk_mul_f32 v[84:85], v[84:85], v[134:135] op_sel_hi:[1,0]
    v_pk_mul_f32 v[114:115], v[114:115], v[136:137] op_sel_hi:[1,0]
    v_pk_mul_f32 v[116:117], v[116:117], v[138:139] op_sel_hi:[1,0]
    v_mov_b32 v167, 0x3f80
    v_cvt_pk_bf16_f32 v152, v84, v85
    v_cvt_pk_bf16_f32 v153, v116, v117
    v_cvt_pk_bf16_f32 v154, v130, -v131
    v_pk_mul_f32 v[140:141], v[84:85], v[84:85] op_sel:[0,0] op_sel_hi:[0,1]
    v_pk_fma_f32 v[86:87], v[84:85], v[84:85], v[140:141] op_sel:[1,1,0] op_sel_hi:[1,0,1] neg_lo:[1,0,0]
    v_cvt_pk_bf16_f32 v155, v86, v87
    v_pk_mul_f32 v[134:135], v[130:131], v[114:115] op_sel:[0,0] op_sel_hi:[0,1]
    v_pk_fma_f32 v[132:133], v[130:131], v[114:115], v[134:135] op_sel:[1,1,0] op_sel_hi:[1,0,1] neg_lo:[1,0,0]
    v_cvt_pk_bf16_f32 v156, v132, -v133
    ds_write_addtid_b32 v167 offset:0
    ds_write_addtid_b32 v152 offset:544
    ds_write_addtid_b32 v153 offset:8704
    ds_write_addtid_b32 v154 offset:26112
    ds_write_addtid_b32 v155 offset:1088
    ds_write_addtid_b32 v156 offset:26656
    v_pk_mul_f32 v[136:137], v[116:117], v[116:117] op_sel:[0,0] op_sel_hi:[0,1]
    v_pk_fma_f32 v[118:119], v[116:117], v[116:117], v[136:137] op_sel:[1,1,0] op_sel_hi:[1,0,1] neg_lo:[1,0,0]
    v_cvt_pk_bf16_f32 v157, v118, v119
    v_pk_mul_f32 v[138:139], v[86:87], v[84:85] op_sel:[0,0] op_sel_hi:[0,1]
    v_pk_fma_f32 v[88:89], v[86:87], v[84:85], v[138:139] op_sel:[1,1,0] op_sel_hi:[1,0,1] neg_lo:[1,0,0]
    v_cvt_pk_bf16_f32 v158, v88, v89
    v_pk_mul_f32 v[140:141], v[132:133], v[114:115] op_sel:[0,0] op_sel_hi:[0,1]
    v_pk_fma_f32 v[130:131], v[132:133], v[114:115], v[140:141] op_sel:[1,1,0] op_sel_hi:[1,0,1] neg_lo:[1,0,0]
    v_cvt_pk_bf16_f32 v159, v130, -v131
    v_pk_mul_f32 v[134:135], v[118:119], v[116:117] op_sel:[0,0] op_sel_hi:[0,1]
    v_pk_fma_f32 v[120:121], v[118:119], v[116:117], v[134:135] op_sel:[1,1,0] op_sel_hi:[1,0,1] neg_lo:[1,0,0]
    v_cvt_pk_bf16_f32 v160, v120, v121
    v_pk_mul_f32 v[136:137], v[86:87], v[86:87] op_sel:[0,0] op_sel_hi:[0,1]
    v_pk_fma_f32 v[90:91], v[86:87], v[86:87], v[136:137] op_sel:[1,1,0] op_sel_hi:[1,0,1] neg_lo:[1,0,0]
    v_cvt_pk_bf16_f32 v161, v90, v91
    v_pk_mul_f32 v[138:139], v[130:131], v[114:115] op_sel:[0,0] op_sel_hi:[0,1]
    v_pk_fma_f32 v[132:133], v[130:131], v[114:115], v[138:139] op_sel:[1,1,0] op_sel_hi:[1,0,1] neg_lo:[1,0,0]
    v_cvt_pk_bf16_f32 v162, v132, -v133
    ds_write_addtid_b32 v157 offset:10336
    ds_write_addtid_b32 v158 offset:1632
    ds_write_addtid_b32 v159 offset:27200
    ds_write_addtid_b32 v160 offset:16320
    ds_write_addtid_b32 v161 offset:2176
    ds_write_addtid_b32 v162 offset:27744
    v_pk_mul_f32 v[140:141], v[118:119], v[118:119] op_sel:[0,0] op_sel_hi:[0,1]
    v_pk_fma_f32 v[122:123], v[118:119], v[118:119], v[140:141] op_sel:[1,1,0] op_sel_hi:[1,0,1] neg_lo:[1,0,0]
    v_cvt_pk_bf16_f32 v163, v122, v123
    v_pk_mul_f32 v[134:135], v[90:91], v[84:85] op_sel:[0,0] op_sel_hi:[0,1]
    v_pk_fma_f32 v[92:93], v[90:91], v[84:85], v[134:135] op_sel:[1,1,0] op_sel_hi:[1,0,1] neg_lo:[1,0,0]
    v_cvt_pk_bf16_f32 v164, v92, v93
    v_pk_mul_f32 v[136:137], v[132:133], v[114:115] op_sel:[0,0] op_sel_hi:[0,1]
    v_pk_fma_f32 v[130:131], v[132:133], v[114:115], v[136:137] op_sel:[1,1,0] op_sel_hi:[1,0,1] neg_lo:[1,0,0]
    v_cvt_pk_bf16_f32 v165, v130, -v131
    v_pk_mul_f32 v[138:139], v[122:123], v[116:117] op_sel:[0,0] op_sel_hi:[0,1]
    v_pk_fma_f32 v[124:125], v[122:123], v[116:117], v[138:139] op_sel:[1,1,0] op_sel_hi:[1,0,1] neg_lo:[1,0,0]
    v_cvt_pk_bf16_f32 v166, v124, v125
    v_pk_mul_f32 v[140:141], v[90:91], v[86:87] op_sel:[0,0] op_sel_hi:[0,1]
    v_pk_fma_f32 v[94:95], v[90:91], v[86:87], v[140:141] op_sel:[1,1,0] op_sel_hi:[1,0,1] neg_lo:[1,0,0]
    v_cvt_pk_bf16_f32 v152, v94, v95
    v_pk_mul_f32 v[134:135], v[130:131], v[114:115] op_sel:[0,0] op_sel_hi:[0,1]
    v_pk_fma_f32 v[132:133], v[130:131], v[114:115], v[134:135] op_sel:[1,1,0] op_sel_hi:[1,0,1] neg_lo:[1,0,0]
    v_cvt_pk_bf16_f32 v153, v132, -v133
    ds_write_addtid_b32 v163 offset:17952
    ds_write_addtid_b32 v164 offset:2720
    ds_write_addtid_b32 v165 offset:28288
    ds_write_addtid_b32 v166 offset:20672
    ds_write_addtid_b32 v152 offset:3264
    ds_write_addtid_b32 v153 offset:28832
    s_waitcnt vmcnt(1)
    s_barrier
    v_pk_mul_f32 v[136:137], v[122:123], v[118:119] op_sel:[0,0] op_sel_hi:[0,1]
    v_pk_fma_f32 v[126:127], v[122:123], v[118:119], v[136:137] op_sel:[1,1,0] op_sel_hi:[1,0,1] neg_lo:[1,0,0]
    v_cvt_pk_bf16_f32 v154, v126, v127
    v_pk_mul_f32 v[138:139], v[90:91], v[88:89] op_sel:[0,0] op_sel_hi:[0,1]
    v_pk_fma_f32 v[96:97], v[90:91], v[88:89], v[138:139] op_sel:[1,1,0] op_sel_hi:[1,0,1] neg_lo:[1,0,0]
    v_cvt_pk_bf16_f32 v155, v96, v97
    v_pk_mul_f32 v[140:141], v[132:133], v[114:115] op_sel:[0,0] op_sel_hi:[0,1]
    v_pk_fma_f32 v[130:131], v[132:133], v[114:115], v[140:141] op_sel:[1,1,0] op_sel_hi:[1,0,1] neg_lo:[1,0,0]
    v_cvt_pk_bf16_f32 v156, v130, -v131
    v_pk_mul_f32 v[134:135], v[122:123], v[120:121] op_sel:[0,0] op_sel_hi:[0,1]
    v_pk_fma_f32 v[128:129], v[122:123], v[120:121], v[134:135] op_sel:[1,1,0] op_sel_hi:[1,0,1] neg_lo:[1,0,0]
    v_cvt_pk_bf16_f32 v157, v128, v129
    v_pk_mul_f32 v[136:137], v[90:91], v[90:91] op_sel:[0,0] op_sel_hi:[0,1]
    v_pk_fma_f32 v[98:99], v[90:91], v[90:91], v[136:137] op_sel:[1,1,0] op_sel_hi:[1,0,1] neg_lo:[1,0,0]
    v_cvt_pk_bf16_f32 v158, v98, v99
    v_pk_mul_f32 v[138:139], v[130:131], v[114:115] op_sel:[0,0] op_sel_hi:[0,1]
    v_pk_fma_f32 v[132:133], v[130:131], v[114:115], v[138:139] op_sel:[1,1,0] op_sel_hi:[1,0,1] neg_lo:[1,0,0]
    v_cvt_pk_bf16_f32 v159, v132, -v133
    ds_write_addtid_b32 v154 offset:22304
    ds_write_addtid_b32 v155 offset:3808
    ds_write_addtid_b32 v156 offset:29376
    ds_write_addtid_b32 v157 offset:23936
    ds_write_addtid_b32 v158 offset:4352
    ds_write_addtid_b32 v159 offset:29920
    v_pk_mul_f32 v[140:141], v[98:99], v[84:85] op_sel:[0,0] op_sel_hi:[0,1]
    v_pk_fma_f32 v[100:101], v[98:99], v[84:85], v[140:141] op_sel:[1,1,0] op_sel_hi:[1,0,1] neg_lo:[1,0,0]
    v_cvt_pk_bf16_f32 v160, v100, v101
    v_pk_mul_f32 v[134:135], v[132:133], v[114:115] op_sel:[0,0] op_sel_hi:[0,1]
    v_pk_fma_f32 v[130:131], v[132:133], v[114:115], v[134:135] op_sel:[1,1,0] op_sel_hi:[1,0,1] neg_lo:[1,0,0]
    v_cvt_pk_bf16_f32 v161, v130, -v131
    v_pk_mul_f32 v[136:137], v[98:99], v[86:87] op_sel:[0,0] op_sel_hi:[0,1]
    v_pk_fma_f32 v[102:103], v[98:99], v[86:87], v[136:137] op_sel:[1,1,0] op_sel_hi:[1,0,1] neg_lo:[1,0,0]
    v_cvt_pk_bf16_f32 v162, v102, v103
    v_pk_mul_f32 v[138:139], v[130:131], v[114:115] op_sel:[0,0] op_sel_hi:[0,1]
    v_pk_fma_f32 v[132:133], v[130:131], v[114:115], v[138:139] op_sel:[1,1,0] op_sel_hi:[1,0,1] neg_lo:[1,0,0]
    v_cvt_pk_bf16_f32 v163, v132, -v133
    v_pk_mul_f32 v[140:141], v[98:99], v[88:89] op_sel:[0,0] op_sel_hi:[0,1]
    v_pk_fma_f32 v[104:105], v[98:99], v[88:89], v[140:141] op_sel:[1,1,0] op_sel_hi:[1,0,1] neg_lo:[1,0,0]
    v_cvt_pk_bf16_f32 v164, v104, v105
    v_pk_mul_f32 v[134:135], v[132:133], v[114:115] op_sel:[0,0] op_sel_hi:[0,1]
    v_pk_fma_f32 v[130:131], v[132:133], v[114:115], v[134:135] op_sel:[1,1,0] op_sel_hi:[1,0,1] neg_lo:[1,0,0]
    v_cvt_pk_bf16_f32 v165, v130, -v131
    ds_write_addtid_b32 v160 offset:4896
    ds_write_addtid_b32 v161 offset:30464
    ds_write_addtid_b32 v162 offset:5440
    ds_write_addtid_b32 v163 offset:31008
    ds_write_addtid_b32 v164 offset:5984
    ds_write_addtid_b32 v165 offset:31552
    v_pk_mul_f32 v[136:137], v[98:99], v[90:91] op_sel:[0,0] op_sel_hi:[0,1]
    v_pk_fma_f32 v[106:107], v[98:99], v[90:91], v[136:137] op_sel:[1,1,0] op_sel_hi:[1,0,1] neg_lo:[1,0,0]
    v_cvt_pk_bf16_f32 v166, v106, v107
    v_pk_mul_f32 v[138:139], v[130:131], v[114:115] op_sel:[0,0] op_sel_hi:[0,1]
    v_pk_fma_f32 v[132:133], v[130:131], v[114:115], v[138:139] op_sel:[1,1,0] op_sel_hi:[1,0,1] neg_lo:[1,0,0]
    v_cvt_pk_bf16_f32 v152, v132, -v133
    v_pk_mul_f32 v[140:141], v[98:99], v[92:93] op_sel:[0,0] op_sel_hi:[0,1]
    v_pk_fma_f32 v[108:109], v[98:99], v[92:93], v[140:141] op_sel:[1,1,0] op_sel_hi:[1,0,1] neg_lo:[1,0,0]
    v_cvt_pk_bf16_f32 v153, v108, v109
    v_pk_mul_f32 v[134:135], v[132:133], v[114:115] op_sel:[0,0] op_sel_hi:[0,1]
    v_pk_fma_f32 v[130:131], v[132:133], v[114:115], v[134:135] op_sel:[1,1,0] op_sel_hi:[1,0,1] neg_lo:[1,0,0]
    v_cvt_pk_bf16_f32 v154, v130, -v131
    v_pk_mul_f32 v[136:137], v[98:99], v[94:95] op_sel:[0,0] op_sel_hi:[0,1]
    v_pk_fma_f32 v[110:111], v[98:99], v[94:95], v[136:137] op_sel:[1,1,0] op_sel_hi:[1,0,1] neg_lo:[1,0,0]
    v_cvt_pk_bf16_f32 v155, v110, v111
    v_pk_mul_f32 v[138:139], v[130:131], v[114:115] op_sel:[0,0] op_sel_hi:[0,1]
    v_pk_fma_f32 v[132:133], v[130:131], v[114:115], v[138:139] op_sel:[1,1,0] op_sel_hi:[1,0,1] neg_lo:[1,0,0]
    v_cvt_pk_bf16_f32 v156, v132, -v133
    ds_write_addtid_b32 v166 offset:6528
    ds_write_addtid_b32 v152 offset:32096
    ds_write_addtid_b32 v153 offset:7072
    ds_write_addtid_b32 v154 offset:32640
    ds_write_addtid_b32 v155 offset:7616
    ds_write_addtid_b32 v156 offset:33184
    v_pk_mul_f32 v[140:141], v[98:99], v[96:97] op_sel:[0,0] op_sel_hi:[0,1]
    v_pk_fma_f32 v[112:113], v[98:99], v[96:97], v[140:141] op_sel:[1,1,0] op_sel_hi:[1,0,1] neg_lo:[1,0,0]
    v_cvt_pk_bf16_f32 v157, v112, v113
    v_pk_mul_f32 v[134:135], v[132:133], v[114:115] op_sel:[0,0] op_sel_hi:[0,1]
    v_pk_fma_f32 v[130:131], v[132:133], v[114:115], v[134:135] op_sel:[1,1,0] op_sel_hi:[1,0,1] neg_lo:[1,0,0]
    v_cvt_pk_bf16_f32 v158, v130, -v131
    v_pk_mul_f32 v[136:137], v[130:131], v[114:115] op_sel:[0,0] op_sel_hi:[0,1]
    v_pk_fma_f32 v[132:133], v[130:131], v[114:115], v[136:137] op_sel:[1,1,0] op_sel_hi:[1,0,1] neg_lo:[1,0,0]
    v_cvt_pk_bf16_f32 v159, v132, -v133
    v_pk_mul_f32 v[138:139], v[116:117], v[86:87] op_sel:[0,0] op_sel_hi:[0,1]
    v_pk_fma_f32 v[146:147], v[116:117], v[86:87], v[138:139] op_sel:[1,1,0] op_sel_hi:[1,0,1] neg_lo:[1,0,0]
    v_cvt_pk_bf16_f32 v160, v146, v147
    v_pk_mul_f32 v[140:141], v[116:117], v[90:91] op_sel:[0,0] op_sel_hi:[0,1]
    v_pk_fma_f32 v[148:149], v[116:117], v[90:91], v[140:141] op_sel:[1,1,0] op_sel_hi:[1,0,1] neg_lo:[1,0,0]
    v_cvt_pk_bf16_f32 v161, v148, v149
    v_pk_mul_f32 v[134:135], v[116:117], v[94:95] op_sel:[0,0] op_sel_hi:[0,1]
    v_pk_fma_f32 v[142:143], v[116:117], v[94:95], v[134:135] op_sel:[1,1,0] op_sel_hi:[1,0,1] neg_lo:[1,0,0]
    v_cvt_pk_bf16_f32 v162, v142, v143
    ds_write_addtid_b32 v157 offset:8160
    ds_write_addtid_b32 v158 offset:33728
    ds_write_addtid_b32 v159 offset:34272
    ds_write_addtid_b32 v160 offset:9248
    ds_write_addtid_b32 v161 offset:9792
    ds_write_addtid_b32 v162 offset:10880
    v_pk_mul_f32 v[136:137], v[116:117], v[98:99] op_sel:[0,0] op_sel_hi:[0,1]
    v_pk_fma_f32 v[144:145], v[116:117], v[98:99], v[136:137] op_sel:[1,1,0] op_sel_hi:[1,0,1] neg_lo:[1,0,0]
    v_cvt_pk_bf16_f32 v163, v144, v145
    v_pk_mul_f32 v[138:139], v[116:117], v[102:103] op_sel:[0,0] op_sel_hi:[0,1]
    v_pk_fma_f32 v[146:147], v[116:117], v[102:103], v[138:139] op_sel:[1,1,0] op_sel_hi:[1,0,1] neg_lo:[1,0,0]
    v_cvt_pk_bf16_f32 v164, v146, v147
    v_pk_mul_f32 v[140:141], v[116:117], v[106:107] op_sel:[0,0] op_sel_hi:[0,1]
    v_pk_fma_f32 v[148:149], v[116:117], v[106:107], v[140:141] op_sel:[1,1,0] op_sel_hi:[1,0,1] neg_lo:[1,0,0]
    v_cvt_pk_bf16_f32 v165, v148, v149
    v_pk_mul_f32 v[134:135], v[116:117], v[110:111] op_sel:[0,0] op_sel_hi:[0,1]
    v_pk_fma_f32 v[142:143], v[116:117], v[110:111], v[134:135] op_sel:[1,1,0] op_sel_hi:[1,0,1] neg_lo:[1,0,0]
    v_cvt_pk_bf16_f32 v166, v142, v143
    v_pk_mul_f32 v[136:137], v[116:117], v[114:115] op_sel:[0,0] op_sel_hi:[0,1]
    v_pk_fma_f32 v[144:145], v[116:117], v[114:115], v[136:137] op_sel:[1,1,0] op_sel_hi:[1,0,1] neg_lo:[1,0,0]
    v_cvt_pk_bf16_f32 v152, v144, v145
    v_pk_mul_f32 v[138:139], v[118:119], v[90:91] op_sel:[0,0] op_sel_hi:[0,1]
    v_pk_fma_f32 v[146:147], v[118:119], v[90:91], v[138:139] op_sel:[1,1,0] op_sel_hi:[1,0,1] neg_lo:[1,0,0]
    v_cvt_pk_bf16_f32 v153, v146, v147
    ds_write_addtid_b32 v163 offset:11424
    ds_write_addtid_b32 v164 offset:13056
    ds_write_addtid_b32 v165 offset:11968
    ds_write_addtid_b32 v166 offset:15232
    ds_write_addtid_b32 v152 offset:15776
    ds_write_addtid_b32 v153 offset:12512
    v_pk_mul_f32 v[140:141], v[118:119], v[98:99] op_sel:[0,0] op_sel_hi:[0,1]
    v_pk_fma_f32 v[148:149], v[118:119], v[98:99], v[140:141] op_sel:[1,1,0] op_sel_hi:[1,0,1] neg_lo:[1,0,0]
    v_cvt_pk_bf16_f32 v154, v148, v149
    v_pk_mul_f32 v[134:135], v[118:119], v[106:107] op_sel:[0,0] op_sel_hi:[0,1]
    v_pk_fma_f32 v[142:143], v[118:119], v[106:107], v[134:135] op_sel:[1,1,0] op_sel_hi:[1,0,1] neg_lo:[1,0,0]
    v_cvt_pk_bf16_f32 v155, v142, v143
    v_pk_mul_f32 v[136:137], v[118:119], v[114:115] op_sel:[0,0] op_sel_hi:[0,1]
    v_pk_fma_f32 v[144:145], v[118:119], v[114:115], v[136:137] op_sel:[1,1,0] op_sel_hi:[1,0,1] neg_lo:[1,0,0]
    v_cvt_pk_bf16_f32 v156, v144, v145
    v_pk_mul_f32 v[138:139], v[120:121], v[90:91] op_sel:[0,0] op_sel_hi:[0,1]
    v_pk_fma_f32 v[146:147], v[120:121], v[90:91], v[138:139] op_sel:[1,1,0] op_sel_hi:[1,0,1] neg_lo:[1,0,0]
    v_cvt_pk_bf16_f32 v157, v146, v147
    v_pk_mul_f32 v[140:141], v[120:121], v[98:99] op_sel:[0,0] op_sel_hi:[0,1]
    v_pk_fma_f32 v[148:149], v[120:121], v[98:99], v[140:141] op_sel:[1,1,0] op_sel_hi:[1,0,1] neg_lo:[1,0,0]
    v_cvt_pk_bf16_f32 v158, v148, v149
    v_pk_mul_f32 v[134:135], v[120:121], v[106:107] op_sel:[0,0] op_sel_hi:[0,1]
    v_pk_fma_f32 v[142:143], v[120:121], v[106:107], v[134:135] op_sel:[1,1,0] op_sel_hi:[1,0,1] neg_lo:[1,0,0]
    v_cvt_pk_bf16_f32 v159, v142, v143
    ds_write_addtid_b32 v154 offset:13600
    ds_write_addtid_b32 v155 offset:14144
    ds_write_addtid_b32 v156 offset:14688
    ds_write_addtid_b32 v157 offset:16864
    ds_write_addtid_b32 v158 offset:17408
    ds_write_addtid_b32 v159 offset:18496
    v_pk_mul_f32 v[136:137], v[120:121], v[114:115] op_sel:[0,0] op_sel_hi:[0,1]
    v_pk_fma_f32 v[144:145], v[120:121], v[114:115], v[136:137] op_sel:[1,1,0] op_sel_hi:[1,0,1] neg_lo:[1,0,0]
    v_cvt_pk_bf16_f32 v160, v144, v145
    v_pk_mul_f32 v[138:139], v[122:123], v[98:99] op_sel:[0,0] op_sel_hi:[0,1]
    v_pk_fma_f32 v[146:147], v[122:123], v[98:99], v[138:139] op_sel:[1,1,0] op_sel_hi:[1,0,1] neg_lo:[1,0,0]
    v_cvt_pk_bf16_f32 v161, v146, v147
    v_pk_mul_f32 v[140:141], v[122:123], v[114:115] op_sel:[0,0] op_sel_hi:[0,1]
    v_pk_fma_f32 v[148:149], v[122:123], v[114:115], v[140:141] op_sel:[1,1,0] op_sel_hi:[1,0,1] neg_lo:[1,0,0]
    v_cvt_pk_bf16_f32 v162, v148, v149
    v_pk_mul_f32 v[134:135], v[124:125], v[98:99] op_sel:[0,0] op_sel_hi:[0,1]
    v_pk_fma_f32 v[142:143], v[124:125], v[98:99], v[134:135] op_sel:[1,1,0] op_sel_hi:[1,0,1] neg_lo:[1,0,0]
    v_cvt_pk_bf16_f32 v163, v142, v143
    v_pk_mul_f32 v[136:137], v[124:125], v[114:115] op_sel:[0,0] op_sel_hi:[0,1]
    v_pk_fma_f32 v[144:145], v[124:125], v[114:115], v[136:137] op_sel:[1,1,0] op_sel_hi:[1,0,1] neg_lo:[1,0,0]
    v_cvt_pk_bf16_f32 v164, v144, v145
    v_pk_mul_f32 v[138:139], v[126:127], v[98:99] op_sel:[0,0] op_sel_hi:[0,1]
    v_pk_fma_f32 v[146:147], v[126:127], v[98:99], v[138:139] op_sel:[1,1,0] op_sel_hi:[1,0,1] neg_lo:[1,0,0]
    v_cvt_pk_bf16_f32 v165, v146, v147
    ds_write_addtid_b32 v160 offset:19584
    ds_write_addtid_b32 v161 offset:19040
    ds_write_addtid_b32 v162 offset:20128
    ds_write_addtid_b32 v163 offset:21216
    ds_write_addtid_b32 v164 offset:21760
    ds_write_addtid_b32 v165 offset:22848
    v_pk_mul_f32 v[140:141], v[126:127], v[114:115] op_sel:[0,0] op_sel_hi:[0,1]
    v_pk_fma_f32 v[148:149], v[126:127], v[114:115], v[140:141] op_sel:[1,1,0] op_sel_hi:[1,0,1] neg_lo:[1,0,0]
    v_cvt_pk_bf16_f32 v166, v148, v149
    v_pk_mul_f32 v[134:135], v[128:129], v[98:99] op_sel:[0,0] op_sel_hi:[0,1]
    v_pk_fma_f32 v[142:143], v[128:129], v[98:99], v[134:135] op_sel:[1,1,0] op_sel_hi:[1,0,1] neg_lo:[1,0,0]
    v_cvt_pk_bf16_f32 v152, v142, v143
    v_pk_mul_f32 v[136:137], v[128:129], v[114:115] op_sel:[0,0] op_sel_hi:[0,1]
    v_pk_fma_f32 v[144:145], v[128:129], v[114:115], v[136:137] op_sel:[1,1,0] op_sel_hi:[1,0,1] neg_lo:[1,0,0]
    v_cvt_pk_bf16_f32 v153, v144, v145
    ds_write_addtid_b32 v166 offset:23392
    ds_write_addtid_b32 v152 offset:25024
    ds_write_addtid_b32 v153 offset:25568
    s_waitcnt lgkmcnt(0)
    s_barrier
    ds_read_b128 v[72:75], v18 offset:26112
    ds_read_b128 v[104:107], v16 offset:0
    ds_read_b128 v[136:139], v17 offset:0
    ds_read_b128 v[76:79], v18 offset:26176
    ds_read_b128 v[108:111], v16 offset:64
    ds_read_b128 v[140:143], v17 offset:64
    ds_read_b128 v[80:83], v18 offset:26240
    ds_read_b128 v[112:115], v16 offset:128
    ds_read_b128 v[144:147], v17 offset:128
    ds_read_b128 v[84:87], v18 offset:26304
    ds_read_b128 v[116:119], v16 offset:192
    ds_read_b128 v[148:151], v17 offset:192
    s_waitcnt lgkmcnt(9)
    v_mfma_f32_16x16x32_bf16 v[40:43], v[104:107], v[72:75], 0
    s_nop 0
    ds_read_b128 v[88:91], v18 offset:26368
    ds_read_b128 v[120:123], v16 offset:256
    v_mfma_f32_16x16x32_bf16 v[44:47], v[136:139], v[72:75], 0
    ds_read_b128 v[152:155], v17 offset:256
    s_waitcnt lgkmcnt(9)
    v_mfma_f32_16x16x32_bf16 v[40:43], v[108:111], v[76:79], v[40:43]
    s_nop 0
    ds_read_b128 v[92:95], v18 offset:26432
    ds_read_b128 v[124:127], v16 offset:320
    v_mfma_f32_16x16x32_bf16 v[44:47], v[140:143], v[76:79], v[44:47]
    ds_read_b128 v[156:159], v17 offset:320
    s_waitcnt lgkmcnt(9)
    v_mfma_f32_16x16x32_bf16 v[40:43], v[112:115], v[80:83], v[40:43]
    s_nop 0
    ds_read_b128 v[96:99], v18 offset:26496
    ds_read_b128 v[128:131], v16 offset:384
    v_mfma_f32_16x16x32_bf16 v[44:47], v[144:147], v[80:83], v[44:47]
    ds_read_b128 v[160:163], v17 offset:384
    s_waitcnt lgkmcnt(9)
    v_mfma_f32_16x16x32_bf16 v[40:43], v[116:119], v[84:87], v[40:43]
    s_nop 0
    ds_read_b128 v[100:103], v18 offset:26560
    ds_read_b128 v[132:135], v16 offset:448
    v_mfma_f32_16x16x32_bf16 v[44:47], v[148:151], v[84:87], v[44:47]
    ds_read_b128 v[164:167], v17 offset:448
    s_waitcnt lgkmcnt(9)
    v_mfma_f32_16x16x32_bf16 v[40:43], v[120:123], v[88:91], v[40:43]
    v_mfma_f32_16x16x32_bf16 v[44:47], v[152:155], v[88:91], v[44:47]
    s_waitcnt lgkmcnt(6)
    v_mfma_f32_16x16x32_bf16 v[40:43], v[124:127], v[92:95], v[40:43]
    v_mfma_f32_16x16x32_bf16 v[44:47], v[156:159], v[92:95], v[44:47]
    s_waitcnt lgkmcnt(3)
    v_mfma_f32_16x16x32_bf16 v[40:43], v[128:131], v[96:99], v[40:43]
    v_mfma_f32_16x16x32_bf16 v[44:47], v[160:163], v[96:99], v[44:47]
    s_waitcnt lgkmcnt(0)
    v_mfma_f32_16x16x32_bf16 v[40:43], v[132:135], v[100:103], v[40:43]
    v_mfma_f32_16x16x32_bf16 v[44:47], v[164:167], v[100:103], v[44:47]
    s_bitcmp1_b32 s37, 0
    v_cmp_eq_u32 vcc, 0, v1
    s_nop 5
    s_cbranch_scc0 L_exp_lo
    v_mov_b32_dpp v178, v45 wave_shr:1 row_mask:0xf bank_mask:0xf bound_ctrl:0
    v_cndmask_b32 v179, v44, 0, vcc
    v_cvt_pk_bf16_f32 v180, v44, v44
    v_cvt_pk_bf16_f32 v181, v44, v44
    v_cvt_pk_bf16_f32 v182, v44, v44
    v_cvt_pk_bf16_f32 v183, v44, v44
    v_cvt_pk_bf16_f32 v184, v44, v44
    v_cvt_pk_bf16_f32 v185, 0, v44
    v_cvt_pk_bf16_f32 v176, v46, v179
    v_cvt_pk_bf16_f32 v177, v45, v178
    v_cvt_pk_bf16_f32 v168, v40, v40
    v_cvt_pk_bf16_f32 v169, v40, v40
    v_cvt_pk_bf16_f32 v170, v40, v40
    v_cvt_pk_bf16_f32 v171, v41, v40
    v_cvt_pk_bf16_f32 v172, v41, v41
    v_cvt_pk_bf16_f32 v173, v41, v41
    v_cvt_pk_bf16_f32 v174, v42, v41
    v_cvt_pk_bf16_f32 v175, v42, v42
    ds_write2_b32 v20, v176, v177 offset0:0 offset1:100
    ds_write_b128 v19, v[168:171]
    ds_write_b128 v19, v[172:175] offset:16
    s_mov_b64 exec, 1
    ds_write_b128 v19, v[180:183] offset:2048
    ds_write_b64 v19, v[184:185] offset:2064
    s_mov_b64 exec, -1
    s_branch L_exp_done
L_exp_lo:
    s_nop 0
    v_mov_b32_dpp v47, v47 row_ror:1 row_mask:0x1 bank_mask:0xf
    v_cvt_pk_bf16_f32 v169, v41, v40
    v_cvt_pk_bf16_f32 v170, v42, v41
    v_cvt_pk_bf16_f32 v171, v43, v42
    v_cndmask_b32 v176, v47, 0, vcc
    v_cndmask_b32_e64 v177, v44, v47, vcc
    v_cvt_pk_bf16_f32 v168, v40, v176
    v_cvt_pk_bf16_f32 v172, v44, v177
    v_cvt_pk_bf16_f32 v173, v44, v44
    v_cvt_pk_bf16_f32 v174, v45, v44
    v_cvt_pk_bf16_f32 v175, v46, v45
    ds_write_b128 v19, v[168:171]
    ds_write_b128 v20, v[172:175]
L_exp_done:
    s_waitcnt lgkmcnt(0)
    s_barrier
    ds_read2_b32 v[72:73], v4 offset0:6 offset1:4
    ds_read2_b32 v[74:75], v4 offset0:2 offset1:0
    ds_read2_b32 v[76:77], v5 offset0:6 offset1:4
    ds_read2_b32 v[78:79], v5 offset0:2 offset1:0
    ds_read2_b32 v[80:81], v6 offset0:6 offset1:4
    ds_read2_b32 v[82:83], v6 offset0:2 offset1:0
    ds_read2_b32 v[84:85], v7 offset0:6 offset1:4
    ds_read2_b32 v[86:87], v7 offset0:2 offset1:0
    ds_read2_b32 v[88:89], v8 offset0:6 offset1:4
    ds_read2_b32 v[90:91], v8 offset0:2 offset1:0
    ds_read2_b32 v[92:93], v10 offset0:18 offset1:16
    ds_read2_b32 v[94:95], v10 offset0:2 offset1:0
    ds_read2_b32 v[96:97], v10 offset0:34 offset1:32
    ds_read2_b32 v[98:99], v10 offset0:18 offset1:16
    ds_read2_b32 v[100:101], v10 offset0:50 offset1:48
    ds_read2_b32 v[102:103], v10 offset0:34 offset1:32
    ds_read2_b32 v[220:221], v10 offset0:66 offset1:64
    ds_read2_b32 v[222:223], v10 offset0:50 offset1:48
    s_waitcnt lgkmcnt(0)
    s_barrier
    s_setprio 2
    s_nop 0
    ds_read_b128 v[164:167], v12 offset:384
    ds_read_b128 v[160:163], v12 offset:896
    ds_read_b128 v[156:159], v12 offset:1408
    ds_read_b128 v[152:155], v12 offset:1920
    ds_read_b128 v[148:151], v12 offset:2432
    ds_read_b128 v[144:147], v12 offset:2944
    ds_read_b128 v[140:143], v12 offset:3456
    ds_read_b128 v[136:139], v12 offset:3968
    s_waitcnt lgkmcnt(7)
    v_mfma_f32_16x16x32_bf16 v[40:43], v[72:75], v[164:167], 0
    v_mfma_f32_16x16x32_bf16 v[44:47], v[76:79], v[164:167], 0
    ds_read_b128 v[196:199], v12 offset:256
    v_mfma_f32_16x16x32_bf16 v[48:51], v[80:83], v[164:167], 0
    ds_read2_b32 v[104:105], v4 offset0:70 offset1:68
    v_mfma_f32_16x16x32_bf16 v[52:55], v[84:87], v[164:167], 0
    ds_read2_b32 v[106:107], v4 offset0:66 offset1:64
    v_mfma_f32_16x16x32_bf16 v[56:59], v[88:91], v[164:167], 0
    ds_read_b128 v[192:195], v12 offset:768
    s_waitcnt lgkmcnt(10)
    v_mfma_f32_16x16x32_bf16 v[44:47], v[72:75], v[160:163], v[44:47]
    ds_read2_b32 v[108:109], v5 offset0:70 offset1:68
    v_mfma_f32_16x16x32_bf16 v[48:51], v[76:79], v[160:163], v[48:51]
    ds_read2_b32 v[110:111], v5 offset0:66 offset1:64
    v_mfma_f32_16x16x32_bf16 v[52:55], v[80:83], v[160:163], v[52:55]
    ds_read_b128 v[188:191], v12 offset:1280
    v_mfma_f32_16x16x32_bf16 v[56:59], v[84:87], v[160:163], v[56:59]
    ds_read2_b32 v[112:113], v6 offset0:70 offset1:68
    v_mfma_f32_16x16x32_bf16 v[60:63], v[88:91], v[160:163], 0
    ds_read2_b32 v[114:115], v6 offset0:66 offset1:64
    s_waitcnt lgkmcnt(14)
    v_mfma_f32_16x16x32_bf16 v[48:51], v[72:75], v[156:159], v[48:51]
    ds_read_b128 v[184:187], v12 offset:1792
    v_mfma_f32_16x16x32_bf16 v[52:55], v[76:79], v[156:159], v[52:55]
    ds_read2_b32 v[116:117], v7 offset0:70 offset1:68
    v_mfma_f32_16x16x32_bf16 v[56:59], v[80:83], v[156:159], v[56:59]
    ds_read2_b32 v[118:119], v7 offset0:66 offset1:64
    v_mfma_f32_16x16x32_bf16 v[60:63], v[84:87], v[156:159], v[60:63]
    ds_read_b128 v[180:183], v12 offset:2304
    v_mfma_f32_16x16x32_bf16 v[64:67], v[88:91], v[156:159], 0
    ds_read_b128 v[176:179], v12 offset:2816
    s_waitcnt lgkmcnt(15)
    v_mfma_f32_16x16x32_bf16 v[52:55], v[72:75], v[152:155], v[52:55]
    ds_read_b128 v[172:175], v12 offset:3328
    v_mfma_f32_16x16x32_bf16 v[56:59], v[76:79], v[152:155], v[56:59]
    ds_read_b128 v[168:171], v12 offset:3840
    v_mfma_f32_16x16x32_bf16 v[60:63], v[80:83], v[152:155], v[60:63]
    ds_read_b128 v[120:123], v9 offset:0
    v_mfma_f32_16x16x32_bf16 v[64:67], v[84:87], v[152:155], v[64:67]
    ds_read_b128 v[124:127], v9 offset:512
    v_mfma_f32_16x16x32_bf16 v[68:71], v[88:91], v[152:155], 0
    ds_read_b128 v[128:131], v9 offset:1024
    s_waitcnt lgkmcnt(15)
    v_mfma_f32_16x16x32_bf16 v[56:59], v[72:75], v[148:151], v[56:59]
    ds_read_b128 v[132:135], v9 offset:1536
    v_mfma_f32_16x16x32_bf16 v[60:63], v[76:79], v[148:151], v[60:63]
    v_mfma_f32_16x16x32_bf16 v[64:67], v[80:83], v[148:151], v[64:67]
    v_mfma_f32_16x16x32_bf16 v[68:71], v[84:87], v[148:151], v[68:71]
    s_waitcnt lgkmcnt(15)
    v_mfma_f32_16x16x32_bf16 v[60:63], v[72:75], v[144:147], v[60:63]
    v_mfma_f32_16x16x32_bf16 v[64:67], v[76:79], v[144:147], v[64:67]
    v_mfma_f32_16x16x32_bf16 v[68:71], v[80:83], v[144:147], v[68:71]
    s_waitcnt lgkmcnt(15)
    v_mfma_f32_16x16x32_bf16 v[64:67], v[72:75], v[140:143], v[64:67]
    v_mfma_f32_16x16x32_bf16 v[68:71], v[76:79], v[140:143], v[68:71]
    s_waitcnt lgkmcnt(15)
    v_mfma_f32_16x16x32_bf16 v[68:71], v[72:75], v[136:139], v[68:71]
    s_waitcnt lgkmcnt(0)
    v_mfma_f32_16x16x32_bf16 v[204:207], v[120:123], v[200:203], 0
    v_mfma_f32_16x16x32_bf16 v[208:211], v[124:127], v[200:203], 0
    ds_read_b128 v[164:167], v12 offset:128
    v_mfma_f32_16x16x32_bf16 v[212:215], v[128:131], v[200:203], 0
    ds_read2_b32 v[72:73], v4 offset0:134 offset1:132
    v_mfma_f32_16x16x32_bf16 v[216:219], v[132:135], v[200:203], 0
    ds_read2_b32 v[74:75], v4 offset0:130 offset1:128
    v_mfma_f32_16x16x32_bf16 v[40:43], v[104:107], v[196:199], v[40:43]
    ds_read_b128 v[160:163], v12 offset:640
    v_mfma_f32_16x16x32_bf16 v[44:47], v[108:111], v[196:199], v[44:47]
    ds_read2_b32 v[76:77], v5 offset0:134 offset1:132
    v_mfma_f32_16x16x32_bf16 v[48:51], v[112:115], v[196:199], v[48:51]
    ds_read2_b32 v[78:79], v5 offset0:130 offset1:128
    v_mfma_f32_16x16x32_bf16 v[52:55], v[116:119], v[196:199], v[52:55]
    ds_read_b128 v[156:159], v12 offset:1152
    v_mfma_f32_16x16x32_bf16 v[44:47], v[104:107], v[192:195], v[44:47]
    ds_read2_b32 v[80:81], v6 offset0:134 offset1:132
    v_mfma_f32_16x16x32_bf16 v[48:51], v[108:111], v[192:195], v[48:51]
    ds_read2_b32 v[82:83], v6 offset0:130 offset1:128
    v_mfma_f32_16x16x32_bf16 v[52:55], v[112:115], v[192:195], v[52:55]
    ds_read_b128 v[152:155], v12 offset:1664
    v_mfma_f32_16x16x32_bf16 v[56:59], v[116:119], v[192:195], v[56:59]
    ds_read2_b32 v[84:85], v7 offset0:134 offset1:132
    v_mfma_f32_16x16x32_bf16 v[48:51], v[104:107], v[188:191], v[48:51]
    ds_read2_b32 v[86:87], v7 offset0:130 offset1:128
    v_cvt_pk_bf16_f32 v120, v204, v205
    v_mfma_f32_16x16x32_bf16 v[52:55], v[108:111], v[188:191], v[52:55]
    ds_read_b128 v[148:151], v12 offset:2176
    v_cvt_pk_bf16_f32 v121, v206, v207
    v_mfma_f32_16x16x32_bf16 v[56:59], v[112:115], v[188:191], v[56:59]
    ds_read_b128 v[144:147], v12 offset:2688
    v_cvt_pk_bf16_f32 v122, v208, v209
    v_mfma_f32_16x16x32_bf16 v[60:63], v[116:119], v[188:191], v[60:63]
    ds_read_b128 v[140:143], v12 offset:3200
    v_cvt_pk_bf16_f32 v123, v210, v211
    v_mfma_f32_16x16x32_bf16 v[52:55], v[104:107], v[184:187], v[52:55]
    ds_read_b128 v[136:139], v12 offset:3712
    v_cvt_pk_bf16_f32 v124, v212, v213
    v_mfma_f32_16x16x32_bf16 v[56:59], v[108:111], v[184:187], v[56:59]
    v_cvt_pk_bf16_f32 v125, v214, v215
    v_mfma_f32_16x16x32_bf16 v[60:63], v[112:115], v[184:187], v[60:63]
    v_cvt_pk_bf16_f32 v126, v216, v217
    v_mfma_f32_16x16x32_bf16 v[64:67], v[116:119], v[184:187], v[64:67]
    v_cvt_pk_bf16_f32 v127, v218, v219
    v_mfma_f32_16x16x32_bf16 v[56:59], v[104:107], v[180:183], v[56:59]
    v_mfma_f32_16x16x32_bf16 v[60:63], v[108:111], v[180:183], v[60:63]
    v_mfma_f32_16x16x32_bf16 v[64:67], v[112:115], v[180:183], v[64:67]
    v_mfma_f32_16x16x32_bf16 v[68:71], v[116:119], v[180:183], v[68:71]
    v_mfma_f32_16x16x32_bf16 v[60:63], v[104:107], v[176:179], v[60:63]
    v_mfma_f32_16x16x32_bf16 v[64:67], v[108:111], v[176:179], v[64:67]
    v_mfma_f32_16x16x32_bf16 v[68:71], v[112:115], v[176:179], v[68:71]
    v_mfma_f32_16x16x32_bf16 v[64:67], v[104:107], v[172:175], v[64:67]
    v_mfma_f32_16x16x32_bf16 v[68:71], v[108:111], v[172:175], v[68:71]
    v_mfma_f32_16x16x32_bf16 v[68:71], v[104:107], v[168:171], v[68:71]
    s_waitcnt lgkmcnt(0)
    v_mfma_f32_16x16x32_bf16 v[56:59], v[120:123], v[92:95], v[56:59]
    v_mfma_f32_16x16x32_bf16 v[60:63], v[120:123], v[96:99], v[60:63]
    ds_read_b128 v[196:199], v12 offset:0
    v_mfma_f32_16x16x32_bf16 v[64:67], v[120:123], v[100:103], v[64:67]
    ds_read2_b32 v[104:105], v4 offset0:198 offset1:196
    v_mfma_f32_16x16x32_bf16 v[68:71], v[120:123], v[220:223], v[68:71]
    ds_read2_b32 v[106:107], v4 offset0:194 offset1:192
    v_mfma_f32_16x16x32_bf16 v[64:67], v[124:127], v[92:95], v[64:67]
    ds_read_b128 v[192:195], v12 offset:512
    v_mfma_f32_16x16x32_bf16 v[68:71], v[124:127], v[96:99], v[68:71]
    ds_read2_b32 v[108:109], v5 offset0:198 offset1:196
    v_mfma_f32_16x16x32_bf16 v[40:43], v[72:75], v[164:167], v[40:43]
    ds_read2_b32 v[110:111], v5 offset0:194 offset1:192
    v_mfma_f32_16x16x32_bf16 v[44:47], v[76:79], v[164:167], v[44:47]
    ds_read_b128 v[188:191], v12 offset:1024
    v_mfma_f32_16x16x32_bf16 v[48:51], v[80:83], v[164:167], v[48:51]
    ds_read2_b32 v[112:113], v6 offset0:198 offset1:196
    v_mfma_f32_16x16x32_bf16 v[52:55], v[84:87], v[164:167], v[52:55]
    ds_read2_b32 v[114:115], v6 offset0:194 offset1:192
    v_mfma_f32_16x16x32_bf16 v[44:47], v[72:75], v[160:163], v[44:47]
    ds_read_b128 v[184:187], v12 offset:1536
    v_mfma_f32_16x16x32_bf16 v[48:51], v[76:79], v[160:163], v[48:51]
    ds_read2_b32 v[116:117], v7 offset0:198 offset1:196
    v_mfma_f32_16x16x32_bf16 v[52:55], v[80:83], v[160:163], v[52:55]
    ds_read2_b32 v[118:119], v7 offset0:194 offset1:192
    v_mfma_f32_16x16x32_bf16 v[56:59], v[84:87], v[160:163], v[56:59]
    ds_read_b128 v[180:183], v12 offset:2048
    v_mfma_f32_16x16x32_bf16 v[48:51], v[72:75], v[156:159], v[48:51]
    ds_read_b128 v[176:179], v12 offset:2560
    v_mfma_f32_16x16x32_bf16 v[52:55], v[76:79], v[156:159], v[52:55]
    ds_read_b128 v[172:175], v12 offset:3072
    v_mfma_f32_16x16x32_bf16 v[56:59], v[80:83], v[156:159], v[56:59]
    ds_read_b128 v[168:171], v12 offset:3584
    v_mfma_f32_16x16x32_bf16 v[60:63], v[84:87], v[156:159], v[60:63]
    v_mfma_f32_16x16x32_bf16 v[52:55], v[72:75], v[152:155], v[52:55]
    v_mfma_f32_16x16x32_bf16 v[56:59], v[76:79], v[152:155], v[56:59]
    v_mfma_f32_16x16x32_bf16 v[60:63], v[80:83], v[152:155], v[60:63]
    v_mfma_f32_16x16x32_bf16 v[64:67], v[84:87], v[152:155], v[64:67]
    v_mfma_f32_16x16x32_bf16 v[56:59], v[72:75], v[148:151], v[56:59]
    v_mfma_f32_16x16x32_bf16 v[60:63], v[76:79], v[148:151], v[60:63]
    v_mfma_f32_16x16x32_bf16 v[64:67], v[80:83], v[148:151], v[64:67]
    v_mfma_f32_16x16x32_bf16 v[68:71], v[84:87], v[148:151], v[68:71]
    v_mfma_f32_16x16x32_bf16 v[60:63], v[72:75], v[144:147], v[60:63]
    v_mfma_f32_16x16x32_bf16 v[64:67], v[76:79], v[144:147], v[64:67]
    v_mfma_f32_16x16x32_bf16 v[68:71], v[80:83], v[144:147], v[68:71]
    v_mfma_f32_16x16x32_bf16 v[64:67], v[72:75], v[140:143], v[64:67]
    v_mfma_f32_16x16x32_bf16 v[68:71], v[76:79], v[140:143], v[68:71]
    v_mfma_f32_16x16x32_bf16 v[68:71], v[72:75], v[136:139], v[68:71]
    s_waitcnt lgkmcnt(0)
    v_mfma_f32_16x16x32_bf16 v[40:43], v[104:107], v[196:199], v[40:43]
    v_mfma_f32_16x16x32_bf16 v[44:47], v[104:107], v[192:195], v[44:47]
    v_mfma_f32_16x16x32_bf16 v[44:47], v[108:111], v[196:199], v[44:47]
    v_mfma_f32_16x16x32_bf16 v[48:51], v[104:107], v[188:191], v[48:51]
    v_mfma_f32_16x16x32_bf16 v[48:51], v[108:111], v[192:195], v[48:51]
    v_mfma_f32_16x16x32_bf16 v[48:51], v[112:115], v[196:199], v[48:51]
    v_mfma_f32_16x16x32_bf16 v[52:55], v[104:107], v[184:187], v[52:55]
    v_mfma_f32_16x16x32_bf16 v[52:55], v[108:111], v[188:191], v[52:55]
    v_mfma_f32_16x16x32_bf16 v[52:55], v[112:115], v[192:195], v[52:55]
    ds_write_b128 v13, v[40:43] offset:0
    v_mfma_f32_16x16x32_bf16 v[52:55], v[116:119], v[196:199], v[52:55]
    v_mfma_f32_16x16x32_bf16 v[56:59], v[104:107], v[180:183], v[56:59]
    ds_write_b128 v13, v[44:47] offset:1152
    v_mfma_f32_16x16x32_bf16 v[56:59], v[108:111], v[184:187], v[56:59]
    v_mfma_f32_16x16x32_bf16 v[56:59], v[112:115], v[188:191], v[56:59]
    v_mfma_f32_16x16x32_bf16 v[56:59], v[116:119], v[192:195], v[56:59]
    ds_write_b128 v13, v[48:51] offset:2304
    v_mfma_f32_16x16x32_bf16 v[60:63], v[104:107], v[176:179], v[60:63]
    v_mfma_f32_16x16x32_bf16 v[60:63], v[108:111], v[180:183], v[60:63]
    v_mfma_f32_16x16x32_bf16 v[60:63], v[112:115], v[184:187], v[60:63]
    v_mfma_f32_16x16x32_bf16 v[60:63], v[116:119], v[188:191], v[60:63]
    ds_write_b128 v13, v[52:55] offset:3456
    v_mfma_f32_16x16x32_bf16 v[64:67], v[104:107], v[172:175], v[64:67]
    v_mfma_f32_16x16x32_bf16 v[64:67], v[108:111], v[176:179], v[64:67]
    v_mfma_f32_16x16x32_bf16 v[64:67], v[112:115], v[180:183], v[64:67]
    v_mfma_f32_16x16x32_bf16 v[64:67], v[116:119], v[184:187], v[64:67]
    ds_write_b128 v13, v[56:59] offset:4608
    v_mfma_f32_16x16x32_bf16 v[68:71], v[104:107], v[168:171], v[68:71]
    v_mfma_f32_16x16x32_bf16 v[68:71], v[108:111], v[172:175], v[68:71]
    v_mfma_f32_16x16x32_bf16 v[68:71], v[112:115], v[176:179], v[68:71]
    v_mfma_f32_16x16x32_bf16 v[68:71], v[116:119], v[180:183], v[68:71]
    ds_write_b128 v13, v[60:63] offset:5760
    s_nop 1
    ds_write_b128 v13, v[64:67] offset:6912
    s_nop 3
    ds_write_b128 v13, v[68:71] offset:8064
    s_waitcnt lgkmcnt(0)
    s_barrier
    s_nop 0
    ds_read_b128 v[72:75], v14 offset:0
    ds_read_b128 v[76:79], v14 offset:9216
    ds_read_b128 v[80:83], v14 offset:18432
    ds_read_b128 v[84:87], v14 offset:27648
    ds_read_b128 v[88:91], v14 offset:1152
    ds_read_b128 v[92:95], v14 offset:10368
    ds_read_b128 v[96:99], v14 offset:19584
    ds_read_b128 v[100:103], v14 offset:28800
    s_waitcnt lgkmcnt(4)
    s_nop 0
    v_pk_add_f32 v[72:73], v[72:73], v[76:77]
    v_pk_add_f32 v[74:75], v[74:75], v[78:79]
    v_pk_add_f32 v[80:81], v[80:81], v[84:85]
    v_pk_add_f32 v[82:83], v[82:83], v[86:87]
    v_cvt_pk_bf16_f32 v104, v72, v73
    v_cvt_pk_bf16_f32 v105, v74, v75
    v_cvt_pk_bf16_f32 v106, v80, v81
    v_cvt_pk_bf16_f32 v107, v82, v83
    global_store_dwordx4 v23, v[104:107], s[32:33] offset:0 sc1
    s_waitcnt lgkmcnt(0)
    s_nop 0
    v_pk_add_f32 v[88:89], v[88:89], v[92:93]
    v_pk_add_f32 v[90:91], v[90:91], v[94:95]
    v_pk_add_f32 v[96:97], v[96:97], v[100:101]
    v_pk_add_f32 v[98:99], v[98:99], v[102:103]
    v_cvt_pk_bf16_f32 v108, v88, v89
    v_cvt_pk_bf16_f32 v109, v90, v91
    v_cvt_pk_bf16_f32 v110, v96, v97
    v_cvt_pk_bf16_f32 v111, v98, v99
    global_store_dwordx4 v23, v[108:111], s[32:33] offset:1024 sc1
    s_barrier
    s_cmp_lt_u32 s37, 2
    s_cbranch_scc0 L_cfin
    v_lshlrev_b32 v29, 4, v1
    v_add_u32 v29, 36864, v29
    v_add_u32 v37, 1024, v29
    v_add_u32 v38, 2048, v29
    v_add_u32 v39, 3072, v29
    s_sub_u32 s66, s34, 0
    v_cmp_eq_u32 s[56:57], s66, v1
    s_sub_u32 s66, s34, 64
    v_cmp_eq_u32 s[58:59], s66, v1
    s_sub_u32 s66, s34, 128
    v_cmp_eq_u32 s[60:61], s66, v1
    s_sub_u32 s66, s34, 192
    v_cmp_eq_u32 s[62:63], s66, v1
    v_mov_b32 v31, 90000
    s_barrier
    s_nop 0
    v_mov_b32 v86, 89984
    ds_read_b128 v[72:75], v15 offset:256
    ds_read_b128 v[76:79], v15 offset:384
    ds_read_b128 v[80:83], v15 offset:512
    ds_read_b32 v87, v86
    s_lshl_b32 s66, s34, 3
    s_sub_u32 s66, 2047, s66
    v_and_b32 v86, 7, v1
    v_sub_u32 v86, s66, v86
    s_waitcnt lgkmcnt(2)
    v_pk_add_f32 v[72:73], v[72:73], v[74:75]
    v_pk_add_f32 v[76:77], v[76:77], v[78:79]
    v_add_f32 v72, v72, v73
    v_add_f32 v76, v76, v77
    v_mul_f32 v72, 0x3b000000, v72
    v_mul_f32 v76, 0x3b000000, v76
    v_fma_f32 v76, -v72, v72, v76
    v_max_f32_e64 v76, 0, v76
    v_cvt_pk_bf16_f32 v100, -v72, v76
    v_and_b32_e64 v76, s49, v100
    v_add_f32 v76, 0x3727c5ac, v76
    v_cvt_pk_bf16_f32 v76, v76, v76
    v_and_b32 v76, s49, v76
    v_sqrt_f32 v76, v76
    v_lshlrev_b32_e64 v84, 16, v100
    v_cvt_pk_bf16_f32 v76, v76, v76
    v_and_b32 v76, s49, v76
    v_rcp_f32_e64 v85, v76
    s_waitcnt lgkmcnt(0)
    v_pk_add_f32 v[80:81], v[80:81], v[82:83]
    v_add_f32 v80, v80, v81
    v_fmac_f32 v80, v84, v87
    v_mul_f32 v80, v80, v85
    v_ashrrev_i32 v81, 31, v80
    v_or_b32 v81, 0x80000000, v81
    v_xor_b32_e64 v80, v80, v81
    v_and_b32 v80, 0xfffff800, v80
    v_or_b32 v80, v80, v86
    v_min_u32_e64 v80, -2, v80
    s_nop 1
    v_max_u32_dpp v80, v80, v80 quad_perm:[1,0,3,2] row_mask:0xf bank_mask:0xf
    s_nop 1
    v_max_u32_dpp v80, v80, v80 quad_perm:[2,3,0,1] row_mask:0xf bank_mask:0xf
    s_nop 1
    v_max_u32_dpp v80, v80, v80 row_half_mirror row_mask:0xf bank_mask:0xf
    s_cmp_eq_u32 s37, 0
    s_cbranch_scc0 L_poll
    s_mov_b64 exec, 1
    global_store_dword v22, v80, s[32:33] sc1
    s_mov_b64 exec, -1
    s_barrier
    s_branch L_keyed
L_poll:
    s_barrier
    s_nop 0
    global_load_dword v72, v29, s[32:33] sc1
    global_load_dword v73, v37, s[32:33] sc1
    global_load_dword v74, v38, s[32:33] sc1
    global_load_dword v75, v39, s[32:33] sc1
    s_waitcnt vmcnt(0)
    s_nop 0
    v_cndmask_b32 v72, v72, v80, s[56:57]
    v_cndmask_b32 v73, v73, v80, s[58:59]
    v_cndmask_b32 v74, v74, v80, s[60:61]
    v_cndmask_b32 v75, v75, v80, s[62:63]
    v_max3_u32 v32, v72, v73, v74
    v_max_u32 v32, v32, v75
    v_cmp_eq_u32_e64 vcc, -1, v32
    s_cbranch_vccnz L_retry_key
L_ok_key:
    v_max_u32_dpp v82, v32, v32 quad_perm:[1,0,3,2] row_mask:0xf bank_mask:0xf
    s_nop 1
    v_max_u32_dpp v82, v82, v82 quad_perm:[2,3,0,1] row_mask:0xf bank_mask:0xf
    s_nop 1
    v_max_u32_dpp v82, v82, v82 row_half_mirror row_mask:0xf bank_mask:0xf
    s_nop 1
    v_max_u32_dpp v82, v82, v82 row_mirror row_mask:0xf bank_mask:0xf
    s_nop 1
    v_max_u32_dpp v82, v82, v82 row_bcast:15 row_mask:0xa bank_mask:0xf
    s_nop 1
    v_max_u32_dpp v82, v82, v82 row_bcast:31 row_mask:0xc bank_mask:0xf
    s_mov_b32 exec_lo, 0
    s_brev_b32 exec_hi, 1
    ds_write_b32 v31, v82 offset:0
    s_mov_b64 exec, -1
    s_waitcnt lgkmcnt(0)
L_keyed:
    s_barrier
L_cfin:
    s_endpgm
L_end:
    s_endpgm
L_retry_x1:
    s_mov_b32 s42, 0x40000
L_again_x1:
    s_sub_u32 s42, s42, 1
    s_cbranch_scc1 L_ok_x1
    s_mov_b64 exec, vcc
    global_load_dwordx4 v[88:91], v24, s[32:33] sc1
    global_load_dwordx4 v[92:95], v25, s[32:33] sc1
    s_waitcnt vmcnt(0)
    v_xor_b32 v132, s56, v88
    v_xor_b32 v133, s57, v89
    v_xor_b32 v134, s58, v90
    v_xor_b32 v135, s59, v91
    v_xor_b32 v136, s56, v92
    v_xor_b32 v137, s57, v93
    v_xor_b32 v138, s58, v94
    v_xor_b32 v139, s59, v95
    ds_write2st64_b64 v30, v[132:133], v[134:135] offset0:0 offset1:9
    ds_write2st64_b64 v30, v[136:137], v[138:139] offset0:4 offset1:13
    v_or3_b32 v38, v132, v133, v134
    v_or3_b32 v39, v135, v136, v137
    v_or3_b32 v38, v38, v138, v139
    v_or_b32_e64 v38, v38, v39
    v_and_b32 v38, 0x60006000, v38
    s_nop 1
    v_or_b32_dpp v38, v38, v38 quad_perm:[1,0,3,2] row_mask:0xf bank_mask:0xf
    v_cmp_ne_u32_e64 vcc, 0, v38
    s_mov_b64 exec, -1
    s_cbranch_vccnz L_again_x1
    s_branch L_ok_x1
L_retry_x2:
    s_mov_b32 s42, 0x40000
L_again_x2:
    s_sub_u32 s42, s42, 1
    s_cbranch_scc1 L_ok_x2
    s_mov_b64 exec, vcc
    global_load_dwordx4 v[88:91], v24, s[32:33] sc1
    global_load_dwordx4 v[92:95], v25, s[32:33] sc1
    s_waitcnt vmcnt(0)
    v_max3_u32 v38, v88, v89, v90
    v_max3_u32 v39, v91, v92, v93
    v_max3_u32 v38, v38, v94, v95
    v_max_u32 v38, v38, v39
    v_cmp_eq_u32_e64 vcc, -1, v38
    s_mov_b64 exec, -1
    s_cbranch_vccnz L_again_x2
    s_branch L_ok_x2
L_retry_sel:
    s_mov_b32 s42, 0x40000
L_again_sel:
    s_sub_u32 s42, s42, 1
    s_cbranch_scc1 L_ok_sel
    s_mov_b64 exec, vcc
    global_load_dwordx4 v[100:103], v32, s[32:33] sc1
    s_waitcnt vmcnt(0)
    v_max3_u32 v38, v100, v101, v102
    v_max_u32 v38, v38, v103
    v_cmp_eq_u32_e64 vcc, -1, v38
    s_mov_b64 exec, -1
    s_cbranch_vccnz L_again_sel
    s_branch L_ok_sel
L_noffn:
    s_cmp_eq_u32 s53, s52
    s_cselect_b32 s3, 8, s3
    s_cmp_eq_u32 s3, 0
    s_cselect_b64 exec, s[64:65], 0
    global_store_dwordx4 v23, v[10:13], s[28:29] offset:-4096 sc1
    s_cmp_eq_u32 s3, 1
    s_cselect_b64 exec, s[64:65], 0
    global_store_dwordx4 v23, v[14:17], s[28:29] offset:0 sc1
    s_mov_b64 exec, -1
L_nofinal:
    s_lshl_b32 s66, s34, 2
    s_add_u32 s66, s66, s37
    s_cmp_eq_u32 s66, 3
    s_cselect_b64 exec, 1, 0
    v_mov_b32 v36, s38
    v_mov_b32_e64 v37, 0
    global_store_dword v37, v36, s[32:33] sc1
    s_branch L_fin
L_retry_xh:
    s_mov_b32 s42, 0x40000
L_again_xh:
    s_sub_u32 s42, s42, 1
    s_cbranch_scc1 L_ok_xh
    s_mov_b64 exec, vcc
    global_load_ushort v120, v33, s[32:33] sc1
    global_load_ushort v121, v33, s[32:33] offset:1024 sc1
    s_waitcnt vmcnt(0)
    v_max_u32 v38, v120, v121
    v_cmp_eq_u32 vcc, 0xffff, v38
    s_mov_b64 exec, -1
    s_cbranch_vccnz L_again_xh
    s_branch L_ok_xh
L_retry_part:
    s_mov_b32 s42, 0x40000
L_again_part:
    s_sub_u32 s42, s42, 1
    s_cbranch_scc1 L_ok_part
    s_mov_b64 exec, vcc
    global_load_dwordx4 v[88:91], v34, s[32:33] sc1
    global_load_dwordx4 v[92:95], v35, s[32:33] sc1
    s_waitcnt vmcnt(0)
    v_max3_u32 v38, v88, v89, v90
    v_max3_u32 v39, v91, v92, v93
    v_max3_u32 v38, v38, v94, v95
    v_max_u32 v38, v38, v39
    v_cmp_eq_u32 vcc, -1, v38
    s_mov_b64 exec, -1
    s_cbranch_vccnz L_again_part
    s_branch L_ok_part
L_retry_key:
    s_mov_b32 s42, 0x40000
L_again_key:
    s_sub_u32 s42, s42, 1
    s_cbranch_scc1 L_ok_key
    s_mov_b64 exec, vcc
    s_nop 0
    global_load_dword v72, v29, s[32:33] sc1
    global_load_dword v73, v37, s[32:33] sc1
    global_load_dword v74, v38, s[32:33] sc1
    global_load_dword v75, v39, s[32:33] sc1
    s_waitcnt vmcnt(0)
    s_nop 0
    v_cndmask_b32 v72, v72, v80, s[56:57]
    v_cndmask_b32 v73, v73, v80, s[58:59]
    v_cndmask_b32 v74, v74, v80, s[60:61]
    v_cndmask_b32 v75, v75, v80, s[62:63]
    v_max3_u32 v32, v72, v73, v74
    v_max_u32 v32, v32, v75
    v_cmp_eq_u32 vcc, -1, v32
    s_mov_b64 exec, -1
    s_cbranch_vccnz L_again_key
    s_branch L_ok_key
L_codeend:
.section .rodata,"a"
.p2align 6
.amdhsa_kernel sequential_preLN__ssm_conv_s4d__moe_arch_mod__prompt_kernel
  .amdhsa_next_free_vgpr 224
  .amdhsa_next_free_sgpr 102
  .amdhsa_accum_offset 224
  .amdhsa_group_segment_fixed_size 0
  .amdhsa_kernarg_size 120
  .amdhsa_user_sgpr_count 2
  .amdhsa_user_sgpr_kernarg_segment_ptr 1
  .amdhsa_system_sgpr_workgroup_id_x 1
.end_amdhsa_kernel
```
